```python
import torch

def _softmax(x, axis=-1):
    return torch.softmax(x, dim=axis)
def _gelu(x):
    return torch.nn.functional.gelu(x, approximate="tanh")
def _silu(x):
    return torch.nn.functional.silu(x)
def _sigmoid(x):
    return torch.sigmoid(x)
def _layernorm(x, axis=-1, eps=1e-5):
    m = x.mean(dim=axis, keepdim=True)
    v = x.var(dim=axis, keepdim=True, unbiased=False)
    return (x - m) / torch.sqrt(v + eps)
def _scatter_add(tgt, idx, src, axis=0):
    return tgt.clone().index_add_(axis, idx, src)
def _segment_sum(src, seg, n):
    out = torch.zeros((n,) + src.shape[1:], dtype=src.dtype)
    return out.index_add_(0, seg, src)
def _pad(x, pw):
    flat = tuple(v for pair in reversed(pw) for v in pair)
    return torch.nn.functional.pad(x, flat)

kernel_name = 'parallel_sum__gqa_block_cached__dense_activation_relu__decode'

def setup_inputs():

    _w = (lambda a: (lambda t: t.to(torch.bfloat16) if t.is_floating_point() else t)(torch.as_tensor(a)))
    def _A_setup():
        B, Sq, D = 1, 1, 448
        Hq, Hkv, Sk, Dh = 16, 8, 32768, 256
        assert Hq % Hkv == 0, (Hq, Hkv)
        return {
            "x": _w((lambda *s: torch.randn(*s, dtype=torch.bfloat16) * 0.05)(B, Sq, D)),
            "k_cache": _w((lambda *s: torch.randn(*s, dtype=torch.bfloat16) * 3.2)(B, Hkv, Sk, Dh)),
            "v_cache": _w((lambda *s: torch.randn(*s, dtype=torch.bfloat16) * 1.6)(B, Hkv, Sk, Dh)),
            "wq": _w((lambda *s: torch.randn(*s, dtype=torch.bfloat16) * 3.2)(D, Hq * Dh) * (D ** -0.5)),
            "wo": _w((lambda *s: torch.randn(*s, dtype=torch.bfloat16) * 1.6)(Hq * Dh, D) * ((Hq * Dh) ** -0.5)),
        }
    _A_in = _A_setup()

    def _B_setup():
        B, S, D, Dff = 1, 1, 448, 1792
        return {
            "x": _w((lambda *s: torch.randn(*s, dtype=torch.bfloat16) * 0.05)(B, S, D)),
            "w1": _w((lambda *s: torch.randn(*s, dtype=torch.bfloat16) * 0.05)(D, Dff)),
            "w2": _w((lambda *s: torch.randn(*s, dtype=torch.bfloat16) * 0.05)(Dff, D)),
        }
    _B_in = _B_setup()

    return {
        "A_x": _A_in["x"],
        "A_k_cache": _A_in["k_cache"],
        "A_v_cache": _A_in["v_cache"],
        "A_wq": _A_in["wq"],
        "A_wo": _A_in["wo"],
        "B_x": _B_in["x"],
        "B_w1": _B_in["w1"],
        "B_w2": _B_in["w2"],
    }

def reference(A_x, A_k_cache, A_v_cache, A_wq, A_wo, B_x, B_w1, B_w2):
    def _A_ref(x, k_cache, v_cache, wq, wo):
        B, Sq, D = x.shape
        Hq, Dh = 16, 256
        Hkv = k_cache.shape[1]
        rep = Hq // Hkv
        q = (lambda x, *d: x.permute(*d))((x @ wq).reshape(B, Sq, Hq, Dh), 0, 2, 1, 3)
        k = (lambda x, n, axis: torch.repeat_interleave(x, n, dim=axis))(k_cache, rep, axis=1)
        v = (lambda x, n, axis: torch.repeat_interleave(x, n, dim=axis))(v_cache, rep, axis=1)
        scores = torch.einsum("bhqd,bhkd->bhqk", q, k) * (Dh ** -0.5)
        p = _softmax(scores, axis=-1)
        o = torch.einsum("bhqk,bhkd->bhqd", p, v)
        return (lambda x, *d: x.permute(*d))(o, 0, 2, 1, 3).reshape(B, Sq, Hq * Dh) @ wo

    def _B_ref(x, w1, w2):
        h = torch.einsum("bsd,df->bsf", x, w1)
        zero = torch.zeros_like(h)
        h = torch.maximum(h, zero)
        return torch.einsum("bsf,fd->bsd", h, w2)

    x = A_x
    xn = _layernorm(x, axis=-1)
    return x + _A_ref(xn, A_k_cache, A_v_cache, A_wq, A_wo) + _B_ref(xn, B_w1, B_w2)
```

```asm
; @launch grid=(256,1,1) block=(256,1,1) lds=160128
.amdgcn_target "amdgcn-amd-amdhsa--gfx950"
.text
.globl parallel_sum__gqa_block_cached__dense_activation_relu__decode_kernel
.p2align 12
.p2align 8
.type parallel_sum__gqa_block_cached__dense_activation_relu__decode_kernel,@function
parallel_sum__gqa_block_cached__dense_activation_relu__decode_kernel:
L_c0:
    s_load_dwordx2 s[28:29], s[0:1], 8
    s_load_dwordx16 s[4:19], s[0:1], 0
    s_load_dwordx4 s[20:23], s[0:1], 64
    s_load_dwordx2 s[24:25], s[0:1], 80
    v_lshrrev_b32 v30, 6, v0
    s_cmp_lt_u32 s2, 92
    s_cbranch_scc1 L_producer
    s_cmp_ge_u32 s2, 256
    s_cbranch_scc1 L_end
    v_and_b32 v1, 63, v0
    v_readfirstlane_b32 s3, v30
    s_and_b32 s60, s2, 7
    s_lshr_b32 s61, s2, 3
    s_and_b32 s72, s61, 7
    s_lshr_b32 s73, s2, 6
    s_lshl_b32 s64, s60, 24
    s_lshl_b32 s74, s72, 19
    s_or_b32 s64, s64, s74
    s_lshl_b32 s74, s73, 15
    s_or_b32 s64, s64, s74
    s_lshl_b32 s74, s3, 11
    s_or_b32 s64, s64, s74
    s_mul_i32 s63, s3, 24576
    s_brev_b32 s30, 16
    s_mov_b32 s31, 0x20000
    v_lshlrev_b32 v29, 4, v1
    v_and_b32 v31, 32, v1
    v_xor_b32 v2, v29, v31
    v_xor_b32 v3, 64, v2
    v_xor_b32 v4, 0x80, v2
    v_xor_b32 v5, 64, v4
    s_waitcnt lgkmcnt(0)
    s_add_u32 m0, s63, 0
    s_add_u32 s67, s64, 0
    buffer_load_dwordx4 v2, s[28:31], s67 offen offset:0 nt lds
    buffer_load_dwordx4 v3, s[28:31], s67 offen offset:1024 nt lds
    s_add_u32 s67, s64, 6144
    buffer_load_dwordx4 v4, s[28:31], s67 offen offset:2048 nt lds
    buffer_load_dwordx4 v5, s[28:31], s67 offen offset:3072 nt lds
    s_add_u32 m0, s63, 4096
    s_add_u32 s67, s64, 16384
    buffer_load_dwordx4 v2, s[28:31], s67 offen offset:0 nt lds
    buffer_load_dwordx4 v3, s[28:31], s67 offen offset:1024 nt lds
    s_add_u32 s67, s64, 22528
    buffer_load_dwordx4 v4, s[28:31], s67 offen offset:2048 nt lds
    buffer_load_dwordx4 v5, s[28:31], s67 offen offset:3072 nt lds
    s_mov_b32 s52, s4
    s_mov_b32 s53, s5
    s_mov_b32 s54, 896
    s_mov_b32 s55, 0x20000
    s_mov_b32 s65, 0x3db8aa3b
    s_min_u32 s66, s2, 223
    s_lshl_b32 s74, s3, 5
    s_add_u32 s74, s74, 159744
    v_lshlrev_b32 v29, 2, v1
    v_add_u32 v29, s74, v29
    v_mov_b32 v30, 0
    s_mov_b64 exec, 0xff
    ds_write_b32 v29, v30
    ds_write_b32 v29, v30 offset:128
    s_mov_b64 exec, -1
    s_waitcnt lgkmcnt(0)
    s_barrier
    s_load_dword s62, s[24:25], 0
    s_mov_b32 s74, 2093056
    s_load_dword s27, s[24:25], s74
    s_lshr_b32 s74, s2, 3
    s_lshl_b32 s74, s74, 2
    s_add_u32 s74, s74, s3
    s_bitcmp1_b32 s74, 3
    s_cselect_b32 s70, s8, s6
    s_cselect_b32 s71, s9, s7
    s_and_b32 s79, s74, 7
    s_lshl_b32 s79, s79, 21
    s_lshl_b32 s80, s60, 24
    s_add_u32 s79, s79, s80
    s_lshl_b32 s80, s74, 7
    s_add_u32 s79, s79, s80
    s_add_u32 s70, s70, s79
    s_addc_u32 s71, s71, 0
    s_load_dword s82, s[70:71], 0x0
    s_bitcmp1_b32 s3, 0
    s_cselect_b32 s70, s12, s18
    s_cselect_b32 s71, s13, s19
    s_mov_b32 s79, 6272
    s_cmov_b32 s79, 14336
    s_mul_i32 s79, s79, s2
    s_add_u32 s70, s70, s79
    s_addc_u32 s71, s71, 0
    s_load_dword s83, s[70:71], 0x0
    s_getpc_b64 s[68:69]
L_pf0:
    s_lshr_b32 s74, s2, 3
    s_lshl_b32 s74, s74, 2
    s_add_u32 s74, s74, s3
    s_lshl_b32 s74, s74, 8
    s_min_u32 s74, s74, L_end-L_c0-128
    s_sub_u32 s68, s68, L_pf0-L_c0
    s_subb_u32 s69, s69, 0
    s_add_u32 s68, s68, s74
    s_addc_u32 s69, s69, 0
    s_load_dword s82, s[68:69], 0x0
    s_load_dword s82, s[68:69], 0x80
    s_mov_b32 s32, s8
    s_mov_b32 s33, s9
    s_mov_b32 s34, 134217728
    s_mov_b32 s35, 0x20000
    s_mov_b32 s40, s12
    s_mov_b32 s41, s13
    s_mov_b32 s42, 3670016
    s_mov_b32 s43, 0x20000
    s_mov_b32 s44, s18
    s_mov_b32 s45, s19
    s_mov_b32 s46, 1605632
    s_mov_b32 s47, 0x20000
    s_mov_b32 s48, s24
    s_mov_b32 s49, s25
    s_mov_b32 s50, 4194304
    s_mov_b32 s51, 0x20000
    s_mov_b32 s56, s20
    s_mov_b32 s57, s21
    s_mov_b32 s58, 896
    s_mov_b32 s59, 0x20000
    v_and_b32 v29, 15, v1
    v_lshrrev_b32 v30, 4, v1
    v_and_b32 v31, 7, v29
    v_lshlrev_b32 v31, 1, v31
    v_xor_b32 v31, v31, v30
    v_lshlrev_b32 v31, 4, v31
    v_lshl_add_u32 v31, v29, 9, v31
    v_xor_b32 v6, 0, v31
    v_add_u32 v6, s63, v6
    v_xor_b32 v7, 64, v31
    v_add_u32 v7, s63, v7
    v_xor_b32 v8, 128, v31
    v_add_u32 v8, s63, v8
    v_xor_b32 v9, 192, v31
    v_add_u32 v9, s63, v9
    v_bfe_u32 v29, v1, 2, 2
    v_lshrrev_b32 v30, 4, v1
    v_xor_b32 v30, v30, v29
    v_and_b32 v31, 3, v1
    v_lshlrev_b32 v31, 3, v31
    v_lshl_add_u32 v31, v30, 5, v31
    v_lshl_add_u32 v31, v29, 9, v31
    v_add_u32 v10, s63, v31
    v_mov_b32 v18, 0xff800000
    s_and_b32 s14, s61, 0
    s_and_b32 s15, s61, 7
    s_mul_i32 s15, s15, 4352
    s_add_u32 s15, s15, 2097152
    s_add_u32 s22, s24, s15
    s_addc_u32 s23, s25, 0
    s_cmp_eq_u32 s3, 1
    s_cselect_b32 s14, s14, 15
    s_mov_b32 s16, 0
    s_mov_b32 s17, 0
    v_mov_b32 v254, 159872
    s_lshl_b32 s74, s2, 2
    s_add_u32 s74, s74, s3
    s_cmp_eq_u32 s74, 1023
    s_cbranch_scc0 L_noclear
    v_mul_u32_u24 v29, 4352, v1
    v_mov_b32 v30, 0
    s_mov_b32 s74, 2097152
    buffer_store_dword v30, v29, s[48:51], s74 offen sc0 sc1
    s_waitcnt vmcnt(0) lgkmcnt(0)
    s_lshl1_add_u32 s74, s27, s62
    s_mul_i32 s74, s74, 1664525
    s_add_u32 s74, s74, 1013904223
    v_mov_b32 v30, s74
    s_mov_b32 s74, 49152
    s_mov_b64 exec, 1
    buffer_store_dword v30, off, s[48:51], s74 sc1
    s_mov_b64 exec, -1
L_noclear:
    s_waitcnt vmcnt(4)
    s_add_u32 m0, s63, 8192
    s_add_u32 s67, s64, 4194304
    buffer_load_dwordx4 v2, s[28:31], s67 offen offset:0 nt lds
    s_waitcnt vmcnt(4)
    buffer_load_dwordx4 v3, s[28:31], s67 offen offset:1024 nt lds
    s_waitcnt vmcnt(4)
    s_add_u32 s67, s64, 4200448
    buffer_load_dwordx4 v4, s[28:31], s67 offen offset:2048 nt lds
    s_waitcnt vmcnt(4)
    buffer_load_dwordx4 v5, s[28:31], s67 offen offset:3072 nt lds
    s_waitcnt vmcnt(4)
    s_add_u32 m0, s63, 12288
    s_add_u32 s67, s64, 4210688
    buffer_load_dwordx4 v2, s[28:31], s67 offen offset:0 nt lds
    ds_read_b128 a[0:3], v6 offset:0
    ds_read_b128 a[4:7], v7 offset:0
    ds_read_b128 a[8:11], v8 offset:0
    ds_read_b128 a[12:15], v9 offset:0
    ds_read_b128 a[16:19], v6 offset:256
    ds_read_b128 a[20:23], v7 offset:256
    ds_read_b128 a[24:27], v8 offset:256
    ds_read_b128 a[28:31], v9 offset:256
    s_waitcnt vmcnt(4)
    buffer_load_dwordx4 v3, s[28:31], s67 offen offset:1024 nt lds
    s_waitcnt lgkmcnt(0)
    s_waitcnt vmcnt(4)
    s_add_u32 s67, s64, 4216832
    buffer_load_dwordx4 v4, s[28:31], s67 offen offset:2048 nt lds
    s_waitcnt vmcnt(4)
    buffer_load_dwordx4 v5, s[28:31], s67 offen offset:3072 nt lds
    s_waitcnt vmcnt(4)
    s_add_u32 m0, s63, 16384
    s_add_u32 s67, s64, 8388608
    buffer_load_dwordx4 v2, s[28:31], s67 offen offset:0 nt lds
    s_waitcnt vmcnt(4)
    buffer_load_dwordx4 v3, s[28:31], s67 offen offset:1024 nt lds
    s_waitcnt vmcnt(4)
    s_add_u32 s67, s64, 8394752
    buffer_load_dwordx4 v4, s[28:31], s67 offen offset:2048 nt lds
    s_waitcnt vmcnt(4)
    buffer_load_dwordx4 v5, s[28:31], s67 offen offset:3072 nt lds
    s_waitcnt vmcnt(4)
    s_add_u32 m0, s63, 20480
    s_add_u32 s67, s64, 8404992
    buffer_load_dwordx4 v2, s[28:31], s67 offen offset:0 nt lds
    ds_read_b128 a[32:35], v6 offset:8192
    ds_read_b128 a[36:39], v7 offset:8192
    ds_read_b128 a[40:43], v8 offset:8192
    ds_read_b128 a[44:47], v9 offset:8192
    ds_read_b128 a[48:51], v6 offset:8448
    ds_read_b128 a[52:55], v7 offset:8448
    ds_read_b128 a[56:59], v8 offset:8448
    ds_read_b128 a[60:63], v9 offset:8448
    s_waitcnt vmcnt(4)
    buffer_load_dwordx4 v3, s[28:31], s67 offen offset:1024 nt lds
    s_waitcnt lgkmcnt(0)
    s_waitcnt vmcnt(4)
    s_add_u32 s67, s64, 8411136
    buffer_load_dwordx4 v4, s[28:31], s67 offen offset:2048 nt lds
    s_waitcnt vmcnt(4)
    buffer_load_dwordx4 v5, s[28:31], s67 offen offset:3072 nt lds
    s_waitcnt vmcnt(4)
    s_add_u32 m0, s63, 0
    s_add_u32 s67, s64, 12582912
    buffer_load_dwordx4 v2, s[28:31], s67 offen offset:0 nt lds
    s_waitcnt vmcnt(4)
    buffer_load_dwordx4 v3, s[28:31], s67 offen offset:1024 nt lds
    s_waitcnt vmcnt(4)
    s_add_u32 s67, s64, 12589056
    buffer_load_dwordx4 v4, s[28:31], s67 offen offset:2048 nt lds
    s_waitcnt vmcnt(4)
    buffer_load_dwordx4 v5, s[28:31], s67 offen offset:3072 nt lds
    s_waitcnt vmcnt(4)
    s_add_u32 m0, s63, 4096
    s_add_u32 s67, s64, 12599296
    buffer_load_dwordx4 v2, s[28:31], s67 offen offset:0 nt lds
    ds_read_b128 a[64:67], v6 offset:16384
    ds_read_b128 a[68:71], v7 offset:16384
    ds_read_b128 a[72:75], v8 offset:16384
    ds_read_b128 a[76:79], v9 offset:16384
    ds_read_b128 a[80:83], v6 offset:16640
    ds_read_b128 a[84:87], v7 offset:16640
    ds_read_b128 a[88:91], v8 offset:16640
    ds_read_b128 a[92:95], v9 offset:16640
    s_waitcnt vmcnt(4)
    buffer_load_dwordx4 v3, s[28:31], s67 offen offset:1024 nt lds
    s_waitcnt lgkmcnt(0)
    s_waitcnt vmcnt(4)
    s_add_u32 s67, s64, 12605440
    buffer_load_dwordx4 v4, s[28:31], s67 offen offset:2048 nt lds
    s_waitcnt vmcnt(4)
    buffer_load_dwordx4 v5, s[28:31], s67 offen offset:3072 nt lds
    s_waitcnt vmcnt(4)
    s_add_u32 m0, s63, 8192
    s_add_u32 s67, s64, 131072
    buffer_load_dwordx4 v2, s[28:31], s67 offen offset:0 nt lds
    s_waitcnt vmcnt(4)
    buffer_load_dwordx4 v3, s[28:31], s67 offen offset:1024 nt lds
    s_waitcnt vmcnt(4)
    s_add_u32 s67, s64, 137216
    buffer_load_dwordx4 v4, s[28:31], s67 offen offset:2048 nt lds
    s_waitcnt vmcnt(4)
    buffer_load_dwordx4 v5, s[28:31], s67 offen offset:3072 nt lds
    s_waitcnt vmcnt(4)
    s_add_u32 m0, s63, 12288
    s_add_u32 s67, s64, 147456
    buffer_load_dwordx4 v2, s[28:31], s67 offen offset:0 nt lds
    ds_read_b128 a[96:99], v6 offset:0
    ds_read_b128 a[100:103], v7 offset:0
    ds_read_b128 a[104:107], v8 offset:0
    ds_read_b128 a[108:111], v9 offset:0
    ds_read_b128 a[112:115], v6 offset:256
    ds_read_b128 a[116:119], v7 offset:256
    ds_read_b128 a[120:123], v8 offset:256
    ds_read_b128 a[124:127], v9 offset:256
    s_waitcnt vmcnt(4)
    buffer_load_dwordx4 v3, s[28:31], s67 offen offset:1024 nt lds
    s_waitcnt lgkmcnt(0)
    s_waitcnt vmcnt(4)
    s_add_u32 s67, s64, 153600
    buffer_load_dwordx4 v4, s[28:31], s67 offen offset:2048 nt lds
    s_waitcnt vmcnt(4)
    buffer_load_dwordx4 v5, s[28:31], s67 offen offset:3072 nt lds
    s_waitcnt vmcnt(4)
    s_add_u32 m0, s63, 16384
    s_add_u32 s67, s64, 4325376
    buffer_load_dwordx4 v2, s[28:31], s67 offen offset:0 nt lds
    s_waitcnt vmcnt(4)
    buffer_load_dwordx4 v3, s[28:31], s67 offen offset:1024 nt lds
    s_waitcnt vmcnt(4)
    s_add_u32 s67, s64, 4331520
    buffer_load_dwordx4 v4, s[28:31], s67 offen offset:2048 nt lds
    s_waitcnt vmcnt(4)
    buffer_load_dwordx4 v5, s[28:31], s67 offen offset:3072 nt lds
    s_waitcnt vmcnt(4)
    s_add_u32 m0, s63, 20480
    s_add_u32 s67, s64, 4341760
    buffer_load_dwordx4 v2, s[28:31], s67 offen offset:0 nt lds
    ds_read_b128 a[128:131], v6 offset:8192
    ds_read_b128 a[132:135], v7 offset:8192
    ds_read_b128 a[136:139], v8 offset:8192
    ds_read_b128 a[140:143], v9 offset:8192
    ds_read_b128 a[144:147], v6 offset:8448
    ds_read_b128 a[148:151], v7 offset:8448
    ds_read_b128 a[152:155], v8 offset:8448
    ds_read_b128 a[156:159], v9 offset:8448
    s_waitcnt vmcnt(4)
    buffer_load_dwordx4 v3, s[28:31], s67 offen offset:1024 nt lds
    s_waitcnt lgkmcnt(0)
    s_waitcnt vmcnt(4)
    s_add_u32 s67, s64, 4347904
    buffer_load_dwordx4 v4, s[28:31], s67 offen offset:2048 nt lds
    s_waitcnt vmcnt(4)
    buffer_load_dwordx4 v5, s[28:31], s67 offen offset:3072 nt lds
    s_waitcnt vmcnt(4)
    s_add_u32 m0, s63, 0
    s_add_u32 s67, s64, 8519680
    buffer_load_dwordx4 v2, s[28:31], s67 offen offset:0 nt lds
    s_waitcnt vmcnt(4)
    buffer_load_dwordx4 v3, s[28:31], s67 offen offset:1024 nt lds
    s_waitcnt vmcnt(4)
    s_add_u32 s67, s64, 8525824
    buffer_load_dwordx4 v4, s[28:31], s67 offen offset:2048 nt lds
    s_waitcnt vmcnt(4)
    buffer_load_dwordx4 v5, s[28:31], s67 offen offset:3072 nt lds
    s_waitcnt vmcnt(4)
    s_add_u32 m0, s63, 4096
    s_add_u32 s67, s64, 8536064
    buffer_load_dwordx4 v2, s[28:31], s67 offen offset:0 nt lds
    ds_read_b128 a[160:163], v6 offset:16384
    ds_read_b128 a[164:167], v7 offset:16384
    ds_read_b128 a[168:171], v8 offset:16384
    ds_read_b128 a[172:175], v9 offset:16384
    ds_read_b128 a[176:179], v6 offset:16640
    ds_read_b128 a[180:183], v7 offset:16640
    ds_read_b128 a[184:187], v8 offset:16640
    ds_read_b128 a[188:191], v9 offset:16640
    s_waitcnt vmcnt(4)
    buffer_load_dwordx4 v3, s[28:31], s67 offen offset:1024 nt lds
    s_waitcnt lgkmcnt(0)
    s_waitcnt vmcnt(4)
    s_add_u32 s67, s64, 8542208
    buffer_load_dwordx4 v4, s[28:31], s67 offen offset:2048 nt lds
    s_waitcnt lgkmcnt(0)
    s_lshl1_add_u32 s62, s27, s62
    s_mul_i32 s62, s62, 1664525
    s_add_u32 s62, s62, 1013904223
    s_waitcnt vmcnt(4)
    buffer_load_dwordx4 v5, s[28:31], s67 offen offset:3072 nt lds
    s_branch L_join
L_producer:
    v_and_b32 v1, 63, v0
    v_readfirstlane_b32 s3, v30
    s_and_b32 s60, s2, 7
    s_lshr_b32 s61, s2, 3
    s_and_b32 s72, s61, 7
    s_lshr_b32 s73, s2, 6
    s_lshl_b32 s64, s60, 24
    s_lshl_b32 s74, s72, 19
    s_or_b32 s64, s64, s74
    s_lshl_b32 s74, s73, 15
    s_or_b32 s64, s64, s74
    s_lshl_b32 s74, s3, 11
    s_or_b32 s64, s64, s74
    s_mul_i32 s63, s3, 24576
    s_brev_b32 s30, 16
    s_mov_b32 s31, 0x20000
    v_lshlrev_b32 v29, 4, v1
    v_and_b32 v31, 32, v1
    v_xor_b32 v2, v29, v31
    v_xor_b32 v3, 64, v2
    v_xor_b32 v4, 0x80, v2
    v_xor_b32 v5, 64, v4
    s_mov_b32 s39, 0x20000
    s_cmp_lt_u32 s2, 64
    s_mov_b32 s38, 1605632
    s_cmov_b32 s38, 3670016
    s_movk_i32 s76, 3584
    s_cmovk_i32 s76, 8192
    s_and_b32 s77, s2, 63
    s_lshl_b32 s77, s77, 7
    s_mul_i32 s78, s3, s76
    s_mulk_i32 s78, 112
    s_add_u32 s77, s77, s78
    v_lshrrev_b32 v30, 3, v1
    v_mul_u32_u24 v30, s76, v30
    v_and_b32 v31, 0x70, v29
    v_add_u32 v21, v31, v30
    s_lshl_b32 s76, s76, 3
    s_mul_i32 s78, s3, 14336
    s_add_u32 s78, s78, 98304
    s_movk_i32 s54, 896
    s_mov_b32 s55, s39
    s_movk_i32 s75, 14
    s_waitcnt lgkmcnt(0)
    s_mov_b64 s[52:53], s[4:5]
    s_cmp_lt_u32 s2, 64
    s_cselect_b64 s[36:37], s[10:11], s[16:17]
    buffer_load_dwordx4 v[224:227], v29, s[52:55], 0 offen
    s_mov_b32 m0, s78
L_stg:
    s_sub_u32 s75, s75, 1
    buffer_load_dwordx4 v21, s[36:39], s77 offen nt lds
    s_add_u32 s77, s77, s76
    s_add_u32 m0, m0, 1024
    s_cmp_lg_u32 s75, 0
    s_cbranch_scc1 L_stg
    s_add_u32 m0, s63, 0
    s_add_u32 s67, s64, 0
    buffer_load_dwordx4 v2, s[28:31], s67 offen offset:0 nt lds
    buffer_load_dwordx4 v3, s[28:31], s67 offen offset:1024 nt lds
    s_add_u32 s67, s64, 6144
    buffer_load_dwordx4 v4, s[28:31], s67 offen offset:2048 nt lds
    buffer_load_dwordx4 v5, s[28:31], s67 offen offset:3072 nt lds
    s_add_u32 m0, s63, 4096
    s_add_u32 s67, s64, 16384
    buffer_load_dwordx4 v2, s[28:31], s67 offen offset:0 nt lds
    buffer_load_dwordx4 v3, s[28:31], s67 offen offset:1024 nt lds
    s_mov_b32 s65, 0x3db8aa3b
    s_min_u32 s66, s2, 223
    s_lshl_b32 s74, s3, 5
    s_add_u32 s74, s74, 159744
    v_lshlrev_b32 v29, 2, v1
    v_add_u32 v29, s74, v29
    v_mov_b32 v30, 0
    s_mov_b64 exec, 0xff
    ds_write_b32 v29, v30
    ds_write_b32 v29, v30 offset:128
    s_mov_b64 exec, -1
    s_waitcnt lgkmcnt(0)
    s_barrier
    s_load_dword s62, s[24:25], 0
    s_mov_b32 s74, 2093056
    s_load_dword s27, s[24:25], s74
    s_lshr_b32 s74, s2, 3
    s_lshl_b32 s74, s74, 2
    s_add_u32 s74, s74, s3
    s_bitcmp1_b32 s74, 3
    s_cselect_b32 s70, s8, s6
    s_cselect_b32 s71, s9, s7
    s_and_b32 s79, s74, 7
    s_lshl_b32 s79, s79, 21
    s_lshl_b32 s80, s60, 24
    s_add_u32 s79, s79, s80
    s_lshl_b32 s80, s74, 7
    s_add_u32 s79, s79, s80
    s_add_u32 s70, s70, s79
    s_addc_u32 s71, s71, 0
    s_load_dword s82, s[70:71], 0x0
    s_bitcmp1_b32 s3, 0
    s_cselect_b32 s70, s12, s18
    s_cselect_b32 s71, s13, s19
    s_mov_b32 s79, 6272
    s_cmov_b32 s79, 14336
    s_mul_i32 s79, s79, s2
    s_add_u32 s70, s70, s79
    s_addc_u32 s71, s71, 0
    s_load_dword s83, s[70:71], 0x0
    s_getpc_b64 s[68:69]
L_pf1:
    s_lshr_b32 s74, s2, 3
    s_lshl_b32 s74, s74, 2
    s_add_u32 s74, s74, s3
    s_lshl_b32 s74, s74, 8
    s_min_u32 s74, s74, L_end-L_c0-128
    s_sub_u32 s68, s68, L_pf1-L_c0
    s_subb_u32 s69, s69, 0
    s_add_u32 s68, s68, s74
    s_addc_u32 s69, s69, 0
    s_load_dword s82, s[68:69], 0x0
    s_load_dword s82, s[68:69], 0x80
    s_mov_b32 s32, s8
    s_mov_b32 s33, s9
    s_mov_b32 s34, 134217728
    s_mov_b32 s35, 0x20000
    s_mov_b32 s40, s12
    s_mov_b32 s41, s13
    s_mov_b32 s42, 3670016
    s_mov_b32 s43, 0x20000
    s_mov_b32 s44, s18
    s_mov_b32 s45, s19
    s_mov_b32 s46, 1605632
    s_mov_b32 s47, 0x20000
    s_mov_b32 s48, s24
    s_mov_b32 s49, s25
    s_mov_b32 s50, 4194304
    s_mov_b32 s51, 0x20000
    s_mov_b32 s56, s20
    s_mov_b32 s57, s21
    s_mov_b32 s58, 896
    s_mov_b32 s59, 0x20000
    v_and_b32 v29, 15, v1
    v_lshrrev_b32 v30, 4, v1
    v_and_b32 v31, 7, v29
    v_lshlrev_b32 v31, 1, v31
    v_xor_b32 v31, v31, v30
    v_lshlrev_b32 v31, 4, v31
    v_lshl_add_u32 v31, v29, 9, v31
    v_xor_b32 v6, 0, v31
    v_add_u32 v6, s63, v6
    v_xor_b32 v7, 64, v31
    v_add_u32 v7, s63, v7
    v_xor_b32 v8, 128, v31
    v_add_u32 v8, s63, v8
    v_xor_b32 v9, 192, v31
    v_add_u32 v9, s63, v9
    v_bfe_u32 v29, v1, 2, 2
    v_lshrrev_b32 v30, 4, v1
    v_xor_b32 v30, v30, v29
    v_and_b32 v31, 3, v1
    v_lshlrev_b32 v31, 3, v31
    v_lshl_add_u32 v31, v30, 5, v31
    v_lshl_add_u32 v31, v29, 9, v31
    v_add_u32 v10, s63, v31
    v_mov_b32 v18, 0xff800000
    s_and_b32 s14, s61, 0
    s_and_b32 s15, s61, 7
    s_mul_i32 s15, s15, 4352
    s_add_u32 s15, s15, 2097152
    s_add_u32 s22, s24, s15
    s_addc_u32 s23, s25, 0
    s_cmp_eq_u32 s3, 1
    s_cselect_b32 s14, s14, 15
    s_mov_b32 s16, 0
    s_mov_b32 s17, 0
    v_mov_b32 v254, 159872
    s_waitcnt vmcnt(20)
    v_lshlrev_b32 v228, 16, v224
    v_and_b32 v229, 0xffff0000, v224
    v_lshlrev_b32 v230, 16, v225
    v_and_b32 v231, 0xffff0000, v225
    v_lshlrev_b32 v232, 16, v226
    v_and_b32 v233, 0xffff0000, v226
    v_lshlrev_b32 v234, 16, v227
    v_and_b32 v235, 0xffff0000, v227
    v_add_f32 v236, v228, v229
    v_add_f32 v236, v236, v230
    v_add_f32 v236, v236, v231
    v_add_f32 v236, v236, v232
    v_add_f32 v236, v236, v233
    v_add_f32 v236, v236, v234
    v_add_f32 v236, v236, v235
    s_nop 1
    v_add_f32_dpp v236, v236, v236 row_ror:1 row_mask:0xf bank_mask:0xf
    s_nop 1
    v_add_f32_dpp v236, v236, v236 row_ror:2 row_mask:0xf bank_mask:0xf
    s_nop 1
    v_add_f32_dpp v236, v236, v236 row_ror:4 row_mask:0xf bank_mask:0xf
    s_nop 1
    v_add_f32_dpp v236, v236, v236 row_ror:8 row_mask:0xf bank_mask:0xf
    v_mov_b32 v237, v236
    s_nop 1
    v_permlane16_swap_b32 v236, v237
    s_nop 0
    v_add_f32 v236, v236, v237
    v_mov_b32 v237, v236
    s_nop 1
    v_permlane32_swap_b32 v236, v237
    s_nop 0
    v_add_f32 v236, v236, v237
    v_mul_f32 v236, 0x3b124925, v236
    v_mov_b32 v237, 0
    v_sub_f32 v238, v228, v236
    v_fmac_f32 v237, v238, v238
    v_sub_f32 v238, v229, v236
    v_fmac_f32 v237, v238, v238
    v_sub_f32 v238, v230, v236
    v_fmac_f32 v237, v238, v238
    v_sub_f32 v238, v231, v236
    v_fmac_f32 v237, v238, v238
    v_sub_f32 v238, v232, v236
    v_fmac_f32 v237, v238, v238
    v_sub_f32 v238, v233, v236
    v_fmac_f32 v237, v238, v238
    v_sub_f32 v238, v234, v236
    v_fmac_f32 v237, v238, v238
    v_sub_f32 v238, v235, v236
    v_fmac_f32 v237, v238, v238
    v_cmp_gt_u32 vcc, 56, v1
    s_nop 1
    v_cndmask_b32 v237, 0, v237, vcc
    s_nop 1
    v_add_f32_dpp v237, v237, v237 row_ror:1 row_mask:0xf bank_mask:0xf
    s_nop 1
    v_add_f32_dpp v237, v237, v237 row_ror:2 row_mask:0xf bank_mask:0xf
    s_nop 1
    v_add_f32_dpp v237, v237, v237 row_ror:4 row_mask:0xf bank_mask:0xf
    s_nop 1
    v_add_f32_dpp v237, v237, v237 row_ror:8 row_mask:0xf bank_mask:0xf
    v_mov_b32 v238, v237
    s_nop 1
    v_permlane16_swap_b32 v237, v238
    s_nop 0
    v_add_f32 v237, v237, v238
    v_mov_b32 v238, v237
    s_nop 1
    v_permlane32_swap_b32 v237, v238
    s_nop 0
    v_add_f32 v237, v237, v238
    v_mul_f32 v237, 0x3b124925, v237
    v_cvt_pk_bf16_f32 v238, v236, v237
    v_lshlrev_b32 v236, 16, v238
    v_and_b32 v237, 0xffff0000, v238
    v_add_f32 v237, 0x3727c5ac, v237
    v_cvt_pk_bf16_f32 v237, v237, v237
    v_and_b32 v237, 0xffff0000, v237
    v_sqrt_f32 v237, v237
    s_nop 0
    v_cvt_pk_bf16_f32 v237, v237, v237
    v_and_b32 v237, 0xffff0000, v237
    v_rcp_f32 v237, v237
    v_sub_f32 v228, v228, v236
    v_sub_f32 v229, v229, v236
    v_sub_f32 v230, v230, v236
    v_sub_f32 v231, v231, v236
    v_sub_f32 v232, v232, v236
    v_sub_f32 v233, v233, v236
    v_sub_f32 v234, v234, v236
    v_sub_f32 v235, v235, v236
    v_cvt_pk_bf16_f32 v224, v228, v229
    v_cvt_pk_bf16_f32 v225, v230, v231
    v_cvt_pk_bf16_f32 v226, v232, v233
    v_cvt_pk_bf16_f32 v227, v234, v235
    v_lshlrev_b32 v228, 16, v224
    v_and_b32 v229, 0xffff0000, v224
    v_lshlrev_b32 v230, 16, v225
    v_and_b32 v231, 0xffff0000, v225
    v_lshlrev_b32 v232, 16, v226
    v_and_b32 v233, 0xffff0000, v226
    v_lshlrev_b32 v234, 16, v227
    v_and_b32 v235, 0xffff0000, v227
    v_mul_f32 v228, v228, v237
    v_mul_f32 v229, v229, v237
    v_mul_f32 v230, v230, v237
    v_mul_f32 v231, v231, v237
    v_mul_f32 v232, v232, v237
    v_mul_f32 v233, v233, v237
    v_mul_f32 v234, v234, v237
    v_mul_f32 v235, v235, v237
    v_cvt_pk_bf16_f32 v224, v228, v229
    v_cvt_pk_bf16_f32 v225, v230, v231
    v_cvt_pk_bf16_f32 v226, v232, v233
    v_cvt_pk_bf16_f32 v227, v234, v235
    s_lshl_b32 s72, s3, 10
    s_add_u32 s72, s72, 155648
    v_lshlrev_b32 v236, 4, v1
    v_add_u32 v236, s72, v236
    ds_write_b128 v236, v[224:227]
    v_lshrrev_b32 v237, 4, v1
    v_lshlrev_b32 v238, 4, v237
    v_add_u32 v238, s72, v238
    s_waitcnt vmcnt(11)
    s_add_u32 s67, s64, 22528
    buffer_load_dwordx4 v4, s[28:31], s67 offen offset:2048 nt lds
    s_waitcnt lgkmcnt(0)
    ds_read_b128 v[96:99], v238 offset:0
    ds_read_b128 v[100:103], v238 offset:64
    ds_read_b128 v[104:107], v238 offset:128
    ds_read_b128 v[108:111], v238 offset:192
    ds_read_b128 v[112:115], v238 offset:256
    ds_read_b128 v[116:119], v238 offset:320
    ds_read_b128 v[120:123], v238 offset:384
    ds_read_b128 v[124:127], v238 offset:448
    ds_read_b128 v[128:131], v238 offset:512
    ds_read_b128 v[132:135], v238 offset:576
    ds_read_b128 v[136:139], v238 offset:640
    ds_read_b128 v[140:143], v238 offset:704
    ds_read_b128 v[144:147], v238 offset:768
    ds_read_b128 v[148:151], v238 offset:832
    v_lshlrev_b32 v237, 10, v237
    v_bfe_u32 v239, v1, 2, 2
    v_lshl_add_u32 v237, v239, 7, v237
    v_and_b32 v239, 3, v1
    v_lshl_add_u32 v237, v239, 3, v237
    s_lshl_b32 s73, s3, 5
    s_add_u32 s73, s73, 98304
    v_add_u32 v237, s73, v237
    s_lshl1_add_u32 s74, s27, s62
    s_mul_i32 s74, s74, 1664525
    s_add_u32 s74, s74, 1013904223
    s_waitcnt vmcnt(11)
    buffer_load_dwordx4 v5, s[28:31], s67 offen offset:3072 nt lds
    s_waitcnt vmcnt(8)
    s_waitcnt lgkmcnt(0)
    s_barrier
    ds_read_b64_tr_b16 v[152:153], v237 offset:0
    ds_read_b64_tr_b16 v[154:155], v237 offset:512
    ds_read_b64_tr_b16 v[156:157], v237 offset:4096
    ds_read_b64_tr_b16 v[158:159], v237 offset:4608
    ds_read_b64_tr_b16 v[160:161], v237 offset:8192
    ds_read_b64_tr_b16 v[162:163], v237 offset:8704
    ds_read_b64_tr_b16 v[164:165], v237 offset:12288
    ds_read_b64_tr_b16 v[166:167], v237 offset:12800
    ds_read_b64_tr_b16 v[168:169], v237 offset:16384
    ds_read_b64_tr_b16 v[170:171], v237 offset:16896
    ds_read_b64_tr_b16 v[172:173], v237 offset:20480
    ds_read_b64_tr_b16 v[174:175], v237 offset:20992
    ds_read_b64_tr_b16 v[176:177], v237 offset:24576
    ds_read_b64_tr_b16 v[178:179], v237 offset:25088
    ds_read_b64_tr_b16 v[180:181], v237 offset:28672
    ds_read_b64_tr_b16 v[182:183], v237 offset:29184
    ds_read_b64_tr_b16 v[184:185], v237 offset:32768
    ds_read_b64_tr_b16 v[186:187], v237 offset:33280
    ds_read_b64_tr_b16 v[188:189], v237 offset:36864
    ds_read_b64_tr_b16 v[190:191], v237 offset:37376
    ds_read_b64_tr_b16 v[192:193], v237 offset:40960
    ds_read_b64_tr_b16 v[194:195], v237 offset:41472
    ds_read_b64_tr_b16 v[196:197], v237 offset:45056
    ds_read_b64_tr_b16 v[198:199], v237 offset:45568
    ds_read_b64_tr_b16 v[200:201], v237 offset:49152
    ds_read_b64_tr_b16 v[202:203], v237 offset:49664
    ds_read_b64_tr_b16 v[204:205], v237 offset:53248
    ds_read_b64_tr_b16 v[206:207], v237 offset:53760
    s_add_u32 m0, s63, 8192
    s_add_u32 s67, s64, 4194304
    buffer_load_dwordx4 v2, s[28:31], s67 offen offset:0 nt lds
    v_and_b32 v239, 15, v1
    v_cmp_eq_u32 s[70:71], 0, v239
    v_lshrrev_b32 v236, 4, v1
    v_lshlrev_b32 v236, 4, v236
    v_mov_b32 v225, s74
    v_mov_b32 v227, s74
    s_lshl_b32 s72, s2, 2
    s_add_u32 s72, s72, s3
    s_lshl_b32 s72, s72, 6
    s_add_u32 s72, s72, 4096
    s_cmp_lt_u32 s2, 64
    s_cselect_b32 s73, 0xff800000, 0
    buffer_load_dwordx4 v3, s[28:31], s67 offen offset:1024 nt lds
    s_waitcnt lgkmcnt(0)
    v_mfma_f32_16x16x32_bf16 v[24:27], v[152:155], v[96:99], 0
    v_mfma_f32_16x16x32_bf16 v[24:27], v[156:159], v[100:103], v[24:27]
    v_mfma_f32_16x16x32_bf16 v[24:27], v[160:163], v[104:107], v[24:27]
    v_mfma_f32_16x16x32_bf16 v[24:27], v[164:167], v[108:111], v[24:27]
    v_mfma_f32_16x16x32_bf16 v[24:27], v[168:171], v[112:115], v[24:27]
    v_mfma_f32_16x16x32_bf16 v[24:27], v[172:175], v[116:119], v[24:27]
    v_mfma_f32_16x16x32_bf16 v[24:27], v[176:179], v[120:123], v[24:27]
    v_mfma_f32_16x16x32_bf16 v[24:27], v[180:183], v[124:127], v[24:27]
    v_mfma_f32_16x16x32_bf16 v[24:27], v[184:187], v[128:131], v[24:27]
    v_mfma_f32_16x16x32_bf16 v[24:27], v[188:191], v[132:135], v[24:27]
    v_mfma_f32_16x16x32_bf16 v[24:27], v[192:195], v[136:139], v[24:27]
    v_mfma_f32_16x16x32_bf16 v[24:27], v[196:199], v[140:143], v[24:27]
    v_mfma_f32_16x16x32_bf16 v[24:27], v[200:203], v[144:147], v[24:27]
    v_mfma_f32_16x16x32_bf16 v[24:27], v[204:207], v[148:151], v[24:27]
    s_add_u32 s67, s64, 4200448
    buffer_load_dwordx4 v4, s[28:31], s67 offen offset:2048 nt lds
    s_nop 7
    v_max_f32 v24, s73, v24
    v_max_f32 v25, s73, v25
    v_max_f32 v26, s73, v26
    v_max_f32 v27, s73, v27
    v_cvt_pk_bf16_f32 v224, v24, v25
    v_cvt_pk_bf16_f32 v226, v26, v27
    s_mov_b64 exec, s[70:71]
    buffer_store_dwordx4 v[224:227], v236, s[48:51], s72 offen sc1
    s_mov_b64 exec, -1
    buffer_load_dwordx4 v5, s[28:31], s67 offen offset:3072 nt lds
    s_waitcnt vmcnt(11)
    s_add_u32 m0, s63, 12288
    s_add_u32 s67, s64, 4210688
    buffer_load_dwordx4 v2, s[28:31], s67 offen offset:0 nt lds
    s_waitcnt vmcnt(11)
    buffer_load_dwordx4 v3, s[28:31], s67 offen offset:1024 nt lds
    s_waitcnt vmcnt(11)
    s_add_u32 s67, s64, 4216832
    buffer_load_dwordx4 v4, s[28:31], s67 offen offset:2048 nt lds
    s_waitcnt vmcnt(11)
    buffer_load_dwordx4 v5, s[28:31], s67 offen offset:3072 nt lds
    s_waitcnt vmcnt(11)
    s_add_u32 m0, s63, 16384
    s_add_u32 s67, s64, 8388608
    buffer_load_dwordx4 v2, s[28:31], s67 offen offset:0 nt lds
    s_waitcnt vmcnt(11)
    buffer_load_dwordx4 v3, s[28:31], s67 offen offset:1024 nt lds
    s_waitcnt vmcnt(11)
    s_add_u32 s67, s64, 8394752
    buffer_load_dwordx4 v4, s[28:31], s67 offen offset:2048 nt lds
    s_waitcnt vmcnt(11)
    buffer_load_dwordx4 v5, s[28:31], s67 offen offset:3072 nt lds
    ds_read_b128 a[0:3], v6 offset:0
    ds_read_b128 a[4:7], v7 offset:0
    ds_read_b128 a[8:11], v8 offset:0
    ds_read_b128 a[12:15], v9 offset:0
    ds_read_b128 a[16:19], v6 offset:256
    ds_read_b128 a[20:23], v7 offset:256
    ds_read_b128 a[24:27], v8 offset:256
    ds_read_b128 a[28:31], v9 offset:256
    s_waitcnt vmcnt(11)
    s_add_u32 m0, s63, 20480
    s_add_u32 s67, s64, 8404992
    buffer_load_dwordx4 v2, s[28:31], s67 offen offset:0 nt lds
    s_waitcnt lgkmcnt(0)
    s_waitcnt vmcnt(11)
    buffer_load_dwordx4 v3, s[28:31], s67 offen offset:1024 nt lds
    s_waitcnt vmcnt(11)
    s_add_u32 s67, s64, 8411136
    buffer_load_dwordx4 v4, s[28:31], s67 offen offset:2048 nt lds
    s_waitcnt vmcnt(11)
    buffer_load_dwordx4 v5, s[28:31], s67 offen offset:3072 nt lds
    s_waitcnt vmcnt(11)
    s_add_u32 m0, s63, 0
    s_add_u32 s67, s64, 12582912
    buffer_load_dwordx4 v2, s[28:31], s67 offen offset:0 nt lds
    s_waitcnt vmcnt(11)
    buffer_load_dwordx4 v3, s[28:31], s67 offen offset:1024 nt lds
    s_waitcnt vmcnt(11)
    s_add_u32 s67, s64, 12589056
    buffer_load_dwordx4 v4, s[28:31], s67 offen offset:2048 nt lds
    s_waitcnt vmcnt(11)
    buffer_load_dwordx4 v5, s[28:31], s67 offen offset:3072 nt lds
    ds_read_b128 a[32:35], v6 offset:8192
    ds_read_b128 a[36:39], v7 offset:8192
    ds_read_b128 a[40:43], v8 offset:8192
    ds_read_b128 a[44:47], v9 offset:8192
    ds_read_b128 a[48:51], v6 offset:8448
    ds_read_b128 a[52:55], v7 offset:8448
    ds_read_b128 a[56:59], v8 offset:8448
    ds_read_b128 a[60:63], v9 offset:8448
    s_waitcnt vmcnt(11)
    s_add_u32 m0, s63, 4096
    s_add_u32 s67, s64, 12599296
    buffer_load_dwordx4 v2, s[28:31], s67 offen offset:0 nt lds
    s_waitcnt lgkmcnt(0)
    s_waitcnt vmcnt(11)
    buffer_load_dwordx4 v3, s[28:31], s67 offen offset:1024 nt lds
    s_waitcnt vmcnt(11)
    s_add_u32 s67, s64, 12605440
    buffer_load_dwordx4 v4, s[28:31], s67 offen offset:2048 nt lds
    s_waitcnt vmcnt(11)
    buffer_load_dwordx4 v5, s[28:31], s67 offen offset:3072 nt lds
    s_waitcnt vmcnt(11)
    s_add_u32 m0, s63, 8192
    s_add_u32 s67, s64, 131072
    buffer_load_dwordx4 v2, s[28:31], s67 offen offset:0 nt lds
    s_waitcnt vmcnt(11)
    buffer_load_dwordx4 v3, s[28:31], s67 offen offset:1024 nt lds
    s_waitcnt vmcnt(11)
    s_add_u32 s67, s64, 137216
    buffer_load_dwordx4 v4, s[28:31], s67 offen offset:2048 nt lds
    s_waitcnt vmcnt(11)
    buffer_load_dwordx4 v5, s[28:31], s67 offen offset:3072 nt lds
    ds_read_b128 a[64:67], v6 offset:16384
    ds_read_b128 a[68:71], v7 offset:16384
    ds_read_b128 a[72:75], v8 offset:16384
    ds_read_b128 a[76:79], v9 offset:16384
    ds_read_b128 a[80:83], v6 offset:16640
    ds_read_b128 a[84:87], v7 offset:16640
    ds_read_b128 a[88:91], v8 offset:16640
    ds_read_b128 a[92:95], v9 offset:16640
    s_waitcnt vmcnt(11)
    s_add_u32 m0, s63, 12288
    s_add_u32 s67, s64, 147456
    buffer_load_dwordx4 v2, s[28:31], s67 offen offset:0 nt lds
    s_waitcnt lgkmcnt(0)
    s_waitcnt vmcnt(11)
    buffer_load_dwordx4 v3, s[28:31], s67 offen offset:1024 nt lds
    s_waitcnt vmcnt(11)
    s_add_u32 s67, s64, 153600
    buffer_load_dwordx4 v4, s[28:31], s67 offen offset:2048 nt lds
    s_waitcnt vmcnt(11)
    buffer_load_dwordx4 v5, s[28:31], s67 offen offset:3072 nt lds
    s_waitcnt vmcnt(11)
    s_add_u32 m0, s63, 16384
    s_add_u32 s67, s64, 4325376
    buffer_load_dwordx4 v2, s[28:31], s67 offen offset:0 nt lds
    s_waitcnt vmcnt(11)
    buffer_load_dwordx4 v3, s[28:31], s67 offen offset:1024 nt lds
    s_waitcnt vmcnt(11)
    s_add_u32 s67, s64, 4331520
    buffer_load_dwordx4 v4, s[28:31], s67 offen offset:2048 nt lds
    s_waitcnt vmcnt(11)
    buffer_load_dwordx4 v5, s[28:31], s67 offen offset:3072 nt lds
    ds_read_b128 a[96:99], v6 offset:0
    ds_read_b128 a[100:103], v7 offset:0
    ds_read_b128 a[104:107], v8 offset:0
    ds_read_b128 a[108:111], v9 offset:0
    ds_read_b128 a[112:115], v6 offset:256
    ds_read_b128 a[116:119], v7 offset:256
    ds_read_b128 a[120:123], v8 offset:256
    ds_read_b128 a[124:127], v9 offset:256
    s_waitcnt vmcnt(11)
    s_add_u32 m0, s63, 20480
    s_add_u32 s67, s64, 4341760
    buffer_load_dwordx4 v2, s[28:31], s67 offen offset:0 nt lds
    s_waitcnt lgkmcnt(0)
    s_waitcnt vmcnt(11)
    buffer_load_dwordx4 v3, s[28:31], s67 offen offset:1024 nt lds
    s_waitcnt vmcnt(11)
    s_add_u32 s67, s64, 4347904
    buffer_load_dwordx4 v4, s[28:31], s67 offen offset:2048 nt lds
    s_waitcnt vmcnt(11)
    buffer_load_dwordx4 v5, s[28:31], s67 offen offset:3072 nt lds
    s_waitcnt vmcnt(11)
    s_add_u32 m0, s63, 0
    s_add_u32 s67, s64, 8519680
    buffer_load_dwordx4 v2, s[28:31], s67 offen offset:0 nt lds
    s_waitcnt vmcnt(11)
    buffer_load_dwordx4 v3, s[28:31], s67 offen offset:1024 nt lds
    s_waitcnt vmcnt(11)
    s_add_u32 s67, s64, 8525824
    buffer_load_dwordx4 v4, s[28:31], s67 offen offset:2048 nt lds
    s_waitcnt vmcnt(11)
    buffer_load_dwordx4 v5, s[28:31], s67 offen offset:3072 nt lds
    ds_read_b128 a[128:131], v6 offset:8192
    ds_read_b128 a[132:135], v7 offset:8192
    ds_read_b128 a[136:139], v8 offset:8192
    ds_read_b128 a[140:143], v9 offset:8192
    ds_read_b128 a[144:147], v6 offset:8448
    ds_read_b128 a[148:151], v7 offset:8448
    ds_read_b128 a[152:155], v8 offset:8448
    ds_read_b128 a[156:159], v9 offset:8448
    s_waitcnt vmcnt(11)
    s_add_u32 m0, s63, 4096
    s_add_u32 s67, s64, 8536064
    buffer_load_dwordx4 v2, s[28:31], s67 offen offset:0 nt lds
    s_waitcnt lgkmcnt(0)
    s_waitcnt vmcnt(11)
    buffer_load_dwordx4 v3, s[28:31], s67 offen offset:1024 nt lds
    s_waitcnt vmcnt(11)
    s_add_u32 s67, s64, 8542208
    buffer_load_dwordx4 v4, s[28:31], s67 offen offset:2048 nt lds
    s_waitcnt vmcnt(11)
    buffer_load_dwordx4 v5, s[28:31], s67 offen offset:3072 nt lds
    s_waitcnt vmcnt(8)
    ds_read_b128 a[160:163], v6 offset:16384
    ds_read_b128 a[164:167], v7 offset:16384
    ds_read_b128 a[168:171], v8 offset:16384
    ds_read_b128 a[172:175], v9 offset:16384
    ds_read_b128 a[176:179], v6 offset:16640
    ds_read_b128 a[180:183], v7 offset:16640
    ds_read_b128 a[184:187], v8 offset:16640
    ds_read_b128 a[188:191], v9 offset:16640
    s_waitcnt lgkmcnt(0)
    s_waitcnt lgkmcnt(0)
    s_lshl1_add_u32 s62, s27, s62
    s_mul_i32 s62, s62, 1664525
    s_add_u32 s62, s62, 1013904223
L_join:
    s_waitcnt vmcnt(4)
    s_add_u32 m0, s63, 8192
    s_add_u32 s67, s64, 12713984
    buffer_load_dwordx4 v2, s[28:31], s67 offen offset:0 nt lds
    s_waitcnt vmcnt(4)
    buffer_load_dwordx4 v3, s[28:31], s67 offen offset:1024 nt lds
    s_waitcnt vmcnt(4)
    s_add_u32 s67, s64, 12720128
    buffer_load_dwordx4 v4, s[28:31], s67 offen offset:2048 nt lds
    s_waitcnt vmcnt(4)
    buffer_load_dwordx4 v5, s[28:31], s67 offen offset:3072 nt lds
    s_waitcnt vmcnt(4)
    s_add_u32 m0, s63, 12288
    s_add_u32 s67, s64, 12730368
    buffer_load_dwordx4 v2, s[28:31], s67 offen offset:0 nt lds
    ds_read_b128 a[192:195], v6 offset:0
    ds_read_b128 a[196:199], v7 offset:0
    ds_read_b128 a[200:203], v8 offset:0
    ds_read_b128 a[204:207], v9 offset:0
    ds_read_b128 a[208:211], v6 offset:256
    ds_read_b128 a[212:215], v7 offset:256
    ds_read_b128 a[216:219], v8 offset:256
    ds_read_b128 a[220:223], v9 offset:256
    s_waitcnt vmcnt(4)
    buffer_load_dwordx4 v3, s[28:31], s67 offen offset:1024 nt lds
    s_waitcnt lgkmcnt(0)
    s_waitcnt vmcnt(4)
    s_add_u32 s67, s64, 12736512
    buffer_load_dwordx4 v4, s[28:31], s67 offen offset:2048 nt lds
    s_lshl_b32 s80, s60, 11
    s_add_u32 s80, s80, 4096
    s_lshl_b32 s79, s66, 5
    s_add_u32 s79, s79, 20480
    v_lshlrev_b32 v232, 4, v1
    s_mov_b32 s78, 49152
    buffer_load_dword v255, off, s[48:51], s78 sc1
    buffer_load_dwordx4 v[224:227], v232, s[48:51], s80 offen sc1
    buffer_load_dwordx4 v[228:231], v232, s[48:51], s80 offen offset:1024 sc1
    buffer_load_dwordx4 v[244:247], off, s[48:51], s79 sc1
    buffer_load_dwordx4 v[248:251], off, s[48:51], s79 offset:16 sc1
    s_waitcnt vmcnt(9)
    buffer_load_dwordx4 v5, s[28:31], s67 offen offset:3072 nt lds
    s_waitcnt vmcnt(9)
    s_add_u32 m0, s63, 16384
    s_add_u32 s67, s64, 262144
    buffer_load_dwordx4 v2, s[28:31], s67 offen offset:0 nt lds
    s_waitcnt vmcnt(9)
    buffer_load_dwordx4 v3, s[28:31], s67 offen offset:1024 nt lds
    s_waitcnt vmcnt(9)
    s_add_u32 s67, s64, 268288
    buffer_load_dwordx4 v4, s[28:31], s67 offen offset:2048 nt lds
    s_waitcnt vmcnt(9)
    buffer_load_dwordx4 v5, s[28:31], s67 offen offset:3072 nt lds
    s_waitcnt vmcnt(4)
    s_add_u32 m0, s63, 20480
    s_add_u32 s67, s64, 278528
    buffer_load_dwordx4 v2, s[28:31], s67 offen offset:0 nt lds
    ds_read_b128 a[224:227], v6 offset:8192
    ds_read_b128 a[228:231], v7 offset:8192
    ds_read_b128 a[232:235], v8 offset:8192
    ds_read_b128 a[236:239], v9 offset:8192
    ds_read_b128 a[240:243], v6 offset:8448
    ds_read_b128 a[244:247], v7 offset:8448
    ds_read_b128 a[248:251], v8 offset:8448
    ds_read_b128 a[252:255], v9 offset:8448
    s_waitcnt vmcnt(4)
    buffer_load_dwordx4 v3, s[28:31], s67 offen offset:1024 nt lds
    s_waitcnt lgkmcnt(0)
    s_waitcnt vmcnt(4)
    s_add_u32 s67, s64, 284672
    buffer_load_dwordx4 v4, s[28:31], s67 offen offset:2048 nt lds
    v_readfirstlane_b32 s78, v255
    s_cmp_eq_u32 s78, s62
    s_cselect_b32 s15, 3, 15
    s_mov_b32 s72, 4000000
L_qchk:
    v_xor_b32 v233, s62, v225
    v_xor_b32 v234, s62, v227
    v_bitop3_b32 v233, v233, v229, s62 bitop3:0xf6
    v_bitop3_b32 v234, v234, v231, s62 bitop3:0xf6
    v_bitop3_b32 v233, v233, v245, s62 bitop3:0xf6
    v_bitop3_b32 v234, v234, v247, s62 bitop3:0xf6
    v_bitop3_b32 v233, v233, v249, s62 bitop3:0xf6
    v_bitop3_b32 v234, v234, v251, s62 bitop3:0xf6
    v_or_b32 v233, v233, v234
    v_cmp_ne_u32 vcc, 0, v233
    s_cbranch_vccz L_qok
    s_sub_u32 s72, s72, 1
    s_cbranch_scc1 L_qok
    buffer_load_dwordx4 v[224:227], v232, s[48:51], s80 offen sc1
    buffer_load_dwordx4 v[228:231], v232, s[48:51], s80 offen offset:1024 sc1
    buffer_load_dwordx4 v[244:247], off, s[48:51], s79 sc1
    buffer_load_dwordx4 v[248:251], off, s[48:51], s79 offset:16 sc1
    s_waitcnt vmcnt(0)
    s_branch L_qchk
L_qok:
    s_lshl_b32 s72, s3, 10
    s_add_u32 s72, s72, 155648
    v_lshlrev_b32 v233, 3, v1
    v_add_u32 v233, s72, v233
    ds_write2_b32 v233, v224, v226 offset0:0 offset1:1
    ds_write2_b32 v233, v228, v230 offset0:128 offset1:129
    v_and_b32 v234, 1, v1
    v_lshlrev_b32 v234, 9, v234
    v_lshrrev_b32 v235, 4, v1
    v_lshl_add_u32 v234, v235, 4, v234
    v_add_u32 v234, s72, v234
    s_waitcnt vmcnt(4)
    buffer_load_dwordx4 v5, s[28:31], s67 offen offset:3072 nt lds
    s_waitcnt lgkmcnt(0)
    ds_read_b128 v[32:35], v234 offset:0
    ds_read_b128 v[36:39], v234 offset:64
    ds_read_b128 v[40:43], v234 offset:128
    ds_read_b128 v[44:47], v234 offset:192
    ds_read_b128 v[48:51], v234 offset:256
    ds_read_b128 v[52:55], v234 offset:320
    ds_read_b128 v[56:59], v234 offset:384
    ds_read_b128 v[60:63], v234 offset:448
    s_waitcnt vmcnt(4)
    s_add_u32 m0, s63, 0
    s_add_u32 s67, s64, 4456448
    buffer_load_dwordx4 v2, s[28:31], s67 offen offset:0 nt lds
    s_waitcnt vmcnt(4)
    buffer_load_dwordx4 v3, s[28:31], s67 offen offset:1024 nt lds
    s_waitcnt vmcnt(4)
    s_add_u32 s67, s64, 4462592
    buffer_load_dwordx4 v4, s[28:31], s67 offen offset:2048 nt lds
    s_waitcnt vmcnt(4)
    buffer_load_dwordx4 v5, s[28:31], s67 offen offset:3072 nt lds
    s_waitcnt vmcnt(4)
    s_add_u32 m0, s63, 4096
    s_add_u32 s67, s64, 4472832
    buffer_load_dwordx4 v2, s[28:31], s67 offen offset:0 nt lds
    v_mov_b32 v255, 1
    s_mov_b64 exec, 1
    ds_add_rtn_u32 v255, v254, v255 offset:8
    s_mov_b64 exec, -1
    ds_read_b128 v[64:67], v6 offset:16384
    ds_read_b128 v[68:71], v7 offset:16384
    ds_read_b128 v[72:75], v8 offset:16384
    ds_read_b128 v[76:79], v9 offset:16384
    ds_read_b128 v[80:83], v6 offset:16640
    ds_read_b128 v[84:87], v7 offset:16640
    ds_read_b128 v[88:91], v8 offset:16640
    ds_read_b128 v[92:95], v9 offset:16640
    s_waitcnt vmcnt(4)
    buffer_load_dwordx4 v3, s[28:31], s67 offen offset:1024 nt lds
    s_waitcnt lgkmcnt(0)
    v_readfirstlane_b32 s14, v255
    s_sub_u32 s14, s14, s15
    s_cmp_eq_u32 s14, 0
    s_cbranch_scc0 L_ra0_8
    s_mov_b32 s18, 1
    s_atomic_add s18, s[22:23], 0 glc
L_ra0_8:
    v_mfma_f32_16x16x32_bf16 v[24:27], v[64:67], v[32:35], 0
    v_mfma_f32_16x16x32_bf16 v[24:27], v[68:71], v[36:39], v[24:27]
    v_mfma_f32_16x16x32_bf16 v[24:27], v[72:75], v[40:43], v[24:27]
    v_mfma_f32_16x16x32_bf16 v[24:27], v[76:79], v[44:47], v[24:27]
    v_mfma_f32_16x16x32_bf16 v[24:27], v[80:83], v[48:51], v[24:27]
    v_mfma_f32_16x16x32_bf16 v[24:27], v[84:87], v[52:55], v[24:27]
    v_mfma_f32_16x16x32_bf16 v[24:27], v[88:91], v[56:59], v[24:27]
    v_mfma_f32_16x16x32_bf16 v[24:27], v[92:95], v[60:63], v[24:27]
    s_waitcnt vmcnt(4)
    s_add_u32 s67, s64, 4478976
    buffer_load_dwordx4 v4, s[28:31], s67 offen offset:2048 nt lds
    s_nop 7
    v_cvt_pk_bf16_f32 v193, v24, v25
    v_cvt_pk_bf16_f32 v195, v26, v27
    v_lshlrev_b32 v192, 16, v193
    v_and_b32 v193, 0xffff0000, v193
    v_lshlrev_b32 v194, 16, v195
    v_and_b32 v195, 0xffff0000, v195
    v_max3_f32 v18, v192, v193, v18
    v_max3_f32 v18, v194, v195, v18
    s_waitcnt vmcnt(4)
    buffer_load_dwordx4 v5, s[28:31], s67 offen offset:3072 nt lds
    v_mfma_f32_16x16x32_bf16 v[24:27], a[0:3], v[32:35], 0
    v_mfma_f32_16x16x32_bf16 v[24:27], a[4:7], v[36:39], v[24:27]
    v_mfma_f32_16x16x32_bf16 v[24:27], a[8:11], v[40:43], v[24:27]
    v_mfma_f32_16x16x32_bf16 v[24:27], a[12:15], v[44:47], v[24:27]
    v_mfma_f32_16x16x32_bf16 v[24:27], a[16:19], v[48:51], v[24:27]
    v_mfma_f32_16x16x32_bf16 v[24:27], a[20:23], v[52:55], v[24:27]
    v_mfma_f32_16x16x32_bf16 v[24:27], a[24:27], v[56:59], v[24:27]
    v_mfma_f32_16x16x32_bf16 v[24:27], a[28:31], v[60:63], v[24:27]
    s_waitcnt vmcnt(4)
    s_add_u32 m0, s63, 8192
    s_add_u32 s67, s64, 8650752
    buffer_load_dwordx4 v2, s[28:31], s67 offen offset:0 nt lds
    s_nop 7
    v_cvt_pk_bf16_f32 v161, v24, v25
    v_cvt_pk_bf16_f32 v163, v26, v27
    v_lshlrev_b32 v160, 16, v161
    v_and_b32 v161, 0xffff0000, v161
    v_lshlrev_b32 v162, 16, v163
    v_and_b32 v163, 0xffff0000, v163
    v_max3_f32 v18, v160, v161, v18
    v_max3_f32 v18, v162, v163, v18
    s_waitcnt vmcnt(4)
    buffer_load_dwordx4 v3, s[28:31], s67 offen offset:1024 nt lds
    v_mfma_f32_16x16x32_bf16 v[24:27], a[32:35], v[32:35], 0
    v_mfma_f32_16x16x32_bf16 v[24:27], a[36:39], v[36:39], v[24:27]
    v_mfma_f32_16x16x32_bf16 v[24:27], a[40:43], v[40:43], v[24:27]
    v_mfma_f32_16x16x32_bf16 v[24:27], a[44:47], v[44:47], v[24:27]
    v_mfma_f32_16x16x32_bf16 v[24:27], a[48:51], v[48:51], v[24:27]
    v_mfma_f32_16x16x32_bf16 v[24:27], a[52:55], v[52:55], v[24:27]
    v_mfma_f32_16x16x32_bf16 v[24:27], a[56:59], v[56:59], v[24:27]
    v_mfma_f32_16x16x32_bf16 v[24:27], a[60:63], v[60:63], v[24:27]
    s_waitcnt vmcnt(4)
    s_add_u32 s67, s64, 8656896
    buffer_load_dwordx4 v4, s[28:31], s67 offen offset:2048 nt lds
    s_nop 7
    v_cvt_pk_bf16_f32 v165, v24, v25
    v_cvt_pk_bf16_f32 v167, v26, v27
    v_lshlrev_b32 v164, 16, v165
    v_and_b32 v165, 0xffff0000, v165
    v_lshlrev_b32 v166, 16, v167
    v_and_b32 v167, 0xffff0000, v167
    v_max3_f32 v18, v164, v165, v18
    v_max3_f32 v18, v166, v167, v18
    s_waitcnt vmcnt(4)
    buffer_load_dwordx4 v5, s[28:31], s67 offen offset:3072 nt lds
    s_waitcnt vmcnt(4)
    s_add_u32 m0, s63, 12288
    s_add_u32 s67, s64, 8667136
    buffer_load_dwordx4 v2, s[28:31], s67 offen offset:0 nt lds
    ds_read_b128 v[64:67], v6 offset:0
    ds_read_b128 v[68:71], v7 offset:0
    ds_read_b128 v[72:75], v8 offset:0
    ds_read_b128 v[76:79], v9 offset:0
    ds_read_b128 v[80:83], v6 offset:256
    ds_read_b128 v[84:87], v7 offset:256
    ds_read_b128 v[88:91], v8 offset:256
    ds_read_b128 v[92:95], v9 offset:256
    s_waitcnt vmcnt(4)
    buffer_load_dwordx4 v3, s[28:31], s67 offen offset:1024 nt lds
    s_waitcnt lgkmcnt(0)
    s_cmp_eq_u32 s14, 0
    s_cbranch_scc0 L_rkd0_0
    s_sub_u32 s16, s18, 14
    s_mul_i32 s16, s16, 8
    s_add_u32 s16, s16, 90
    s_cmp_gt_u32 s18, 14
    s_cselect_b32 s16, s16, 0
    s_sub_u32 s17, s18, 24
    s_mul_i32 s17, s17, 8
    s_add_u32 s17, s17, 90
    s_cmp_gt_u32 s18, 24
    s_cselect_b32 s17, s17, 0
    v_mov_b32 v242, s16
    v_mov_b32 v243, s17
    ds_write_b64 v254, v[242:243]
L_rkd0_0:
    v_mfma_f32_16x16x32_bf16 v[24:27], v[64:67], v[32:35], 0
    v_mfma_f32_16x16x32_bf16 v[24:27], v[68:71], v[36:39], v[24:27]
    v_mfma_f32_16x16x32_bf16 v[24:27], v[72:75], v[40:43], v[24:27]
    v_mfma_f32_16x16x32_bf16 v[24:27], v[76:79], v[44:47], v[24:27]
    v_mfma_f32_16x16x32_bf16 v[24:27], v[80:83], v[48:51], v[24:27]
    v_mfma_f32_16x16x32_bf16 v[24:27], v[84:87], v[52:55], v[24:27]
    v_mfma_f32_16x16x32_bf16 v[24:27], v[88:91], v[56:59], v[24:27]
    v_mfma_f32_16x16x32_bf16 v[24:27], v[92:95], v[60:63], v[24:27]
    s_cmp_gt_u32 s17, 86
    s_cbranch_scc1 L_x86
    s_waitcnt vmcnt(5)
    s_cmp_gt_u32 s16, 86
    s_cbranch_scc1 L_x86
    s_waitcnt vmcnt(4)
L_x86:
    s_add_u32 s67, s64, 8673280
    buffer_load_dwordx4 v4, s[28:31], s67 offen offset:2048 nt lds
    s_nop 7
    v_cvt_pk_bf16_f32 v197, v24, v25
    v_cvt_pk_bf16_f32 v199, v26, v27
    v_lshlrev_b32 v196, 16, v197
    v_and_b32 v197, 0xffff0000, v197
    v_lshlrev_b32 v198, 16, v199
    v_and_b32 v199, 0xffff0000, v199
    v_max3_f32 v18, v196, v197, v18
    v_max3_f32 v18, v198, v199, v18
    s_cmp_gt_u32 s17, 87
    s_cbranch_scc1 L_x87
    s_waitcnt vmcnt(5)
    s_cmp_gt_u32 s16, 87
    s_cbranch_scc1 L_x87
    s_waitcnt vmcnt(4)
L_x87:
    buffer_load_dwordx4 v5, s[28:31], s67 offen offset:3072 nt lds
    v_mfma_f32_16x16x32_bf16 v[24:27], a[64:67], v[32:35], 0
    v_mfma_f32_16x16x32_bf16 v[24:27], a[68:71], v[36:39], v[24:27]
    v_mfma_f32_16x16x32_bf16 v[24:27], a[72:75], v[40:43], v[24:27]
    v_mfma_f32_16x16x32_bf16 v[24:27], a[76:79], v[44:47], v[24:27]
    v_mfma_f32_16x16x32_bf16 v[24:27], a[80:83], v[48:51], v[24:27]
    v_mfma_f32_16x16x32_bf16 v[24:27], a[84:87], v[52:55], v[24:27]
    v_mfma_f32_16x16x32_bf16 v[24:27], a[88:91], v[56:59], v[24:27]
    v_mfma_f32_16x16x32_bf16 v[24:27], a[92:95], v[60:63], v[24:27]
    s_cmp_gt_u32 s17, 88
    s_cbranch_scc1 L_x88
    s_waitcnt vmcnt(5)
    s_cmp_gt_u32 s16, 88
    s_cbranch_scc1 L_x88
    s_waitcnt vmcnt(4)
L_x88:
    s_add_u32 m0, s63, 16384
    s_add_u32 s67, s64, 12845056
    buffer_load_dwordx4 v2, s[28:31], s67 offen offset:0 nt lds
    s_nop 7
    v_cvt_pk_bf16_f32 v169, v24, v25
    v_cvt_pk_bf16_f32 v171, v26, v27
    v_lshlrev_b32 v168, 16, v169
    v_and_b32 v169, 0xffff0000, v169
    v_lshlrev_b32 v170, 16, v171
    v_and_b32 v171, 0xffff0000, v171
    v_max3_f32 v18, v168, v169, v18
    v_max3_f32 v18, v170, v171, v18
    s_waitcnt vmcnt(7)
    s_cmp_gt_u32 s17, 89
    s_cbranch_scc1 L_x89
    s_waitcnt vmcnt(5)
    s_cmp_gt_u32 s16, 89
    s_cbranch_scc1 L_x89
    s_waitcnt vmcnt(4)
L_x89:
    buffer_load_dwordx4 v3, s[28:31], s67 offen offset:1024 nt lds
    v_mfma_f32_16x16x32_bf16 v[24:27], a[96:99], v[32:35], 0
    v_mfma_f32_16x16x32_bf16 v[24:27], a[100:103], v[36:39], v[24:27]
    v_mfma_f32_16x16x32_bf16 v[24:27], a[104:107], v[40:43], v[24:27]
    v_mfma_f32_16x16x32_bf16 v[24:27], a[108:111], v[44:47], v[24:27]
    v_mfma_f32_16x16x32_bf16 v[24:27], a[112:115], v[48:51], v[24:27]
    v_mfma_f32_16x16x32_bf16 v[24:27], a[116:119], v[52:55], v[24:27]
    v_mfma_f32_16x16x32_bf16 v[24:27], a[120:123], v[56:59], v[24:27]
    v_mfma_f32_16x16x32_bf16 v[24:27], a[124:127], v[60:63], v[24:27]
    s_waitcnt vmcnt(7)
    s_cmp_gt_u32 s17, 90
    s_cbranch_scc1 L_x90
    s_waitcnt vmcnt(5)
    s_cmp_gt_u32 s16, 90
    s_cbranch_scc1 L_x90
    s_waitcnt vmcnt(4)
L_x90:
    s_add_u32 s67, s64, 12851200
    buffer_load_dwordx4 v4, s[28:31], s67 offen offset:2048 nt lds
    s_nop 7
    v_cvt_pk_bf16_f32 v173, v24, v25
    v_cvt_pk_bf16_f32 v175, v26, v27
    v_lshlrev_b32 v172, 16, v173
    v_and_b32 v173, 0xffff0000, v173
    v_lshlrev_b32 v174, 16, v175
    v_and_b32 v175, 0xffff0000, v175
    v_max3_f32 v18, v172, v173, v18
    v_max3_f32 v18, v174, v175, v18
    s_waitcnt vmcnt(7)
    s_cmp_gt_u32 s17, 91
    s_cbranch_scc1 L_x91
    s_waitcnt vmcnt(5)
    s_cmp_gt_u32 s16, 91
    s_cbranch_scc1 L_x91
    s_waitcnt vmcnt(4)
L_x91:
    buffer_load_dwordx4 v5, s[28:31], s67 offen offset:3072 nt lds
    s_waitcnt vmcnt(7)
    s_cmp_gt_u32 s17, 92
    s_cbranch_scc1 L_x92
    s_waitcnt vmcnt(5)
    s_cmp_gt_u32 s16, 92
    s_cbranch_scc1 L_x92
    s_waitcnt vmcnt(4)
L_x92:
    s_add_u32 m0, s63, 20480
    s_add_u32 s67, s64, 12861440
    buffer_load_dwordx4 v2, s[28:31], s67 offen offset:0 nt lds
    s_waitcnt vmcnt(7)
    s_cmp_gt_u32 s17, 93
    s_cbranch_scc1 L_x93
    s_waitcnt vmcnt(5)
    s_cmp_gt_u32 s16, 93
    s_cbranch_scc1 L_x93
    s_waitcnt vmcnt(4)
L_x93:
    buffer_load_dwordx4 v3, s[28:31], s67 offen offset:1024 nt lds
    s_waitcnt vmcnt(7)
    s_cmp_gt_u32 s17, 94
    s_cbranch_scc1 L_x94
    s_waitcnt vmcnt(5)
    s_cmp_gt_u32 s16, 94
    s_cbranch_scc1 L_x94
    s_waitcnt vmcnt(4)
L_x94:
    s_add_u32 s67, s64, 12867584
    buffer_load_dwordx4 v4, s[28:31], s67 offen offset:2048 nt lds
    s_waitcnt vmcnt(7)
    s_cmp_gt_u32 s17, 95
    s_cbranch_scc1 L_x95
    s_waitcnt vmcnt(5)
    s_cmp_gt_u32 s16, 95
    s_cbranch_scc1 L_x95
    s_waitcnt vmcnt(4)
L_x95:
    buffer_load_dwordx4 v5, s[28:31], s67 offen offset:3072 nt lds
    ds_read_b64 v[242:243], v254
    ds_read_b128 v[64:67], v6 offset:8192
    ds_read_b128 v[68:71], v7 offset:8192
    ds_read_b128 v[72:75], v8 offset:8192
    ds_read_b128 v[76:79], v9 offset:8192
    ds_read_b128 v[80:83], v6 offset:8448
    ds_read_b128 v[84:87], v7 offset:8448
    ds_read_b128 v[88:91], v8 offset:8448
    ds_read_b128 v[92:95], v9 offset:8448
    s_waitcnt vmcnt(7)
    s_cmp_gt_u32 s17, 96
    s_cbranch_scc1 L_x96
    s_waitcnt vmcnt(5)
    s_cmp_gt_u32 s16, 96
    s_cbranch_scc1 L_x96
    s_waitcnt vmcnt(4)
L_x96:
    s_add_u32 m0, s63, 0
    s_add_u32 s67, s64, 393216
    buffer_load_dwordx4 v2, s[28:31], s67 offen offset:0 nt lds
    s_waitcnt lgkmcnt(0)
    v_readfirstlane_b32 s16, v242
    v_readfirstlane_b32 s17, v243
    v_mfma_f32_16x16x32_bf16 v[24:27], v[64:67], v[32:35], 0
    v_mfma_f32_16x16x32_bf16 v[24:27], v[68:71], v[36:39], v[24:27]
    v_mfma_f32_16x16x32_bf16 v[24:27], v[72:75], v[40:43], v[24:27]
    v_mfma_f32_16x16x32_bf16 v[24:27], v[76:79], v[44:47], v[24:27]
    v_mfma_f32_16x16x32_bf16 v[24:27], v[80:83], v[48:51], v[24:27]
    v_mfma_f32_16x16x32_bf16 v[24:27], v[84:87], v[52:55], v[24:27]
    v_mfma_f32_16x16x32_bf16 v[24:27], v[88:91], v[56:59], v[24:27]
    v_mfma_f32_16x16x32_bf16 v[24:27], v[92:95], v[60:63], v[24:27]
    s_waitcnt vmcnt(7)
    s_cmp_gt_u32 s17, 97
    s_cbranch_scc1 L_x97
    s_waitcnt vmcnt(5)
    s_cmp_gt_u32 s16, 97
    s_cbranch_scc1 L_x97
    s_waitcnt vmcnt(4)
L_x97:
    buffer_load_dwordx4 v3, s[28:31], s67 offen offset:1024 nt lds
    s_nop 7
    v_cvt_pk_bf16_f32 v201, v24, v25
    v_cvt_pk_bf16_f32 v203, v26, v27
    v_lshlrev_b32 v200, 16, v201
    v_and_b32 v201, 0xffff0000, v201
    v_lshlrev_b32 v202, 16, v203
    v_and_b32 v203, 0xffff0000, v203
    v_max3_f32 v18, v200, v201, v18
    v_max3_f32 v18, v202, v203, v18
    s_waitcnt vmcnt(7)
    s_cmp_gt_u32 s17, 98
    s_cbranch_scc1 L_x98
    s_waitcnt vmcnt(5)
    s_cmp_gt_u32 s16, 98
    s_cbranch_scc1 L_x98
    s_waitcnt vmcnt(4)
L_x98:
    s_add_u32 s67, s64, 399360
    buffer_load_dwordx4 v4, s[28:31], s67 offen offset:2048 nt lds
    v_mfma_f32_16x16x32_bf16 v[24:27], a[128:131], v[32:35], 0
    v_mfma_f32_16x16x32_bf16 v[24:27], a[132:135], v[36:39], v[24:27]
    v_mfma_f32_16x16x32_bf16 v[24:27], a[136:139], v[40:43], v[24:27]
    v_mfma_f32_16x16x32_bf16 v[24:27], a[140:143], v[44:47], v[24:27]
    v_mfma_f32_16x16x32_bf16 v[24:27], a[144:147], v[48:51], v[24:27]
    v_mfma_f32_16x16x32_bf16 v[24:27], a[148:151], v[52:55], v[24:27]
    v_mfma_f32_16x16x32_bf16 v[24:27], a[152:155], v[56:59], v[24:27]
    v_mfma_f32_16x16x32_bf16 v[24:27], a[156:159], v[60:63], v[24:27]
    s_waitcnt vmcnt(7)
    s_cmp_gt_u32 s17, 99
    s_cbranch_scc1 L_x99
    s_waitcnt vmcnt(5)
    s_cmp_gt_u32 s16, 99
    s_cbranch_scc1 L_x99
    s_waitcnt vmcnt(4)
L_x99:
    buffer_load_dwordx4 v5, s[28:31], s67 offen offset:3072 nt lds
    s_nop 7
    v_cvt_pk_bf16_f32 v177, v24, v25
    v_cvt_pk_bf16_f32 v179, v26, v27
    v_lshlrev_b32 v176, 16, v177
    v_and_b32 v177, 0xffff0000, v177
    v_lshlrev_b32 v178, 16, v179
    v_and_b32 v179, 0xffff0000, v179
    v_max3_f32 v18, v176, v177, v18
    v_max3_f32 v18, v178, v179, v18
    s_waitcnt vmcnt(7)
    s_cmp_gt_u32 s17, 100
    s_cbranch_scc1 L_x100
    s_waitcnt vmcnt(5)
    s_cmp_gt_u32 s16, 100
    s_cbranch_scc1 L_x100
    s_waitcnt vmcnt(4)
L_x100:
    s_add_u32 m0, s63, 4096
    s_add_u32 s67, s64, 409600
    buffer_load_dwordx4 v2, s[28:31], s67 offen offset:0 nt lds
    v_mfma_f32_16x16x32_bf16 v[24:27], a[160:163], v[32:35], 0
    v_mfma_f32_16x16x32_bf16 v[24:27], a[164:167], v[36:39], v[24:27]
    v_mfma_f32_16x16x32_bf16 v[24:27], a[168:171], v[40:43], v[24:27]
    v_mfma_f32_16x16x32_bf16 v[24:27], a[172:175], v[44:47], v[24:27]
    v_mfma_f32_16x16x32_bf16 v[24:27], a[176:179], v[48:51], v[24:27]
    v_mfma_f32_16x16x32_bf16 v[24:27], a[180:183], v[52:55], v[24:27]
    v_mfma_f32_16x16x32_bf16 v[24:27], a[184:187], v[56:59], v[24:27]
    v_mfma_f32_16x16x32_bf16 v[24:27], a[188:191], v[60:63], v[24:27]
    s_waitcnt vmcnt(7)
    s_cmp_gt_u32 s17, 101
    s_cbranch_scc1 L_x101
    s_waitcnt vmcnt(5)
    s_cmp_gt_u32 s16, 101
    s_cbranch_scc1 L_x101
    s_waitcnt vmcnt(4)
L_x101:
    buffer_load_dwordx4 v3, s[28:31], s67 offen offset:1024 nt lds
    s_nop 7
    v_cvt_pk_bf16_f32 v181, v24, v25
    v_cvt_pk_bf16_f32 v183, v26, v27
    v_lshlrev_b32 v180, 16, v181
    v_and_b32 v181, 0xffff0000, v181
    v_lshlrev_b32 v182, 16, v183
    v_and_b32 v183, 0xffff0000, v183
    v_max3_f32 v18, v180, v181, v18
    v_max3_f32 v18, v182, v183, v18
    s_waitcnt vmcnt(7)
    s_cmp_gt_u32 s17, 102
    s_cbranch_scc1 L_x102
    s_waitcnt vmcnt(5)
    s_cmp_gt_u32 s16, 102
    s_cbranch_scc1 L_x102
    s_waitcnt vmcnt(4)
L_x102:
    s_add_u32 s67, s64, 415744
    buffer_load_dwordx4 v4, s[28:31], s67 offen offset:2048 nt lds
    s_waitcnt vmcnt(7)
    s_cmp_gt_u32 s17, 103
    s_cbranch_scc1 L_x103
    s_waitcnt vmcnt(5)
    s_cmp_gt_u32 s16, 103
    s_cbranch_scc1 L_x103
    s_waitcnt vmcnt(4)
L_x103:
    buffer_load_dwordx4 v5, s[28:31], s67 offen offset:3072 nt lds
    ds_read_b64 v[242:243], v254
    ds_read_b128 v[64:67], v6 offset:16384
    ds_read_b128 v[68:71], v7 offset:16384
    ds_read_b128 v[72:75], v8 offset:16384
    ds_read_b128 v[76:79], v9 offset:16384
    ds_read_b128 v[80:83], v6 offset:16640
    ds_read_b128 v[84:87], v7 offset:16640
    ds_read_b128 v[88:91], v8 offset:16640
    ds_read_b128 v[92:95], v9 offset:16640
    s_waitcnt vmcnt(7)
    s_cmp_gt_u32 s17, 104
    s_cbranch_scc1 L_x104
    s_waitcnt vmcnt(5)
    s_cmp_gt_u32 s16, 104
    s_cbranch_scc1 L_x104
    s_waitcnt vmcnt(4)
L_x104:
    s_add_u32 m0, s63, 8192
    s_add_u32 s67, s64, 4587520
    buffer_load_dwordx4 v2, s[28:31], s67 offen offset:0 nt lds
    s_waitcnt lgkmcnt(0)
    v_readfirstlane_b32 s16, v242
    v_readfirstlane_b32 s17, v243
    v_mfma_f32_16x16x32_bf16 v[24:27], v[64:67], v[32:35], 0
    v_mfma_f32_16x16x32_bf16 v[24:27], v[68:71], v[36:39], v[24:27]
    v_mfma_f32_16x16x32_bf16 v[24:27], v[72:75], v[40:43], v[24:27]
    v_mfma_f32_16x16x32_bf16 v[24:27], v[76:79], v[44:47], v[24:27]
    v_mfma_f32_16x16x32_bf16 v[24:27], v[80:83], v[48:51], v[24:27]
    v_mfma_f32_16x16x32_bf16 v[24:27], v[84:87], v[52:55], v[24:27]
    v_mfma_f32_16x16x32_bf16 v[24:27], v[88:91], v[56:59], v[24:27]
    v_mfma_f32_16x16x32_bf16 v[24:27], v[92:95], v[60:63], v[24:27]
    s_waitcnt vmcnt(7)
    s_cmp_gt_u32 s17, 105
    s_cbranch_scc1 L_x105
    s_waitcnt vmcnt(5)
    s_cmp_gt_u32 s16, 105
    s_cbranch_scc1 L_x105
    s_waitcnt vmcnt(4)
L_x105:
    buffer_load_dwordx4 v3, s[28:31], s67 offen offset:1024 nt lds
    s_nop 7
    v_cvt_pk_bf16_f32 v205, v24, v25
    v_cvt_pk_bf16_f32 v207, v26, v27
    v_lshlrev_b32 v204, 16, v205
    v_and_b32 v205, 0xffff0000, v205
    v_lshlrev_b32 v206, 16, v207
    v_and_b32 v207, 0xffff0000, v207
    v_max3_f32 v18, v204, v205, v18
    v_max3_f32 v18, v206, v207, v18
    s_waitcnt vmcnt(7)
    s_cmp_gt_u32 s17, 106
    s_cbranch_scc1 L_x106
    s_waitcnt vmcnt(5)
    s_cmp_gt_u32 s16, 106
    s_cbranch_scc1 L_x106
    s_waitcnt vmcnt(4)
L_x106:
    s_add_u32 s67, s64, 4593664
    buffer_load_dwordx4 v4, s[28:31], s67 offen offset:2048 nt lds
    v_mfma_f32_16x16x32_bf16 v[24:27], a[192:195], v[32:35], 0
    v_mfma_f32_16x16x32_bf16 v[24:27], a[196:199], v[36:39], v[24:27]
    v_mfma_f32_16x16x32_bf16 v[24:27], a[200:203], v[40:43], v[24:27]
    v_mfma_f32_16x16x32_bf16 v[24:27], a[204:207], v[44:47], v[24:27]
    v_mfma_f32_16x16x32_bf16 v[24:27], a[208:211], v[48:51], v[24:27]
    v_mfma_f32_16x16x32_bf16 v[24:27], a[212:215], v[52:55], v[24:27]
    v_mfma_f32_16x16x32_bf16 v[24:27], a[216:219], v[56:59], v[24:27]
    v_mfma_f32_16x16x32_bf16 v[24:27], a[220:223], v[60:63], v[24:27]
    s_waitcnt vmcnt(7)
    s_cmp_gt_u32 s17, 107
    s_cbranch_scc1 L_x107
    s_waitcnt vmcnt(5)
    s_cmp_gt_u32 s16, 107
    s_cbranch_scc1 L_x107
    s_waitcnt vmcnt(4)
L_x107:
    buffer_load_dwordx4 v5, s[28:31], s67 offen offset:3072 nt lds
    s_nop 7
    v_cvt_pk_bf16_f32 v185, v24, v25
    v_cvt_pk_bf16_f32 v187, v26, v27
    v_lshlrev_b32 v184, 16, v185
    v_and_b32 v185, 0xffff0000, v185
    v_lshlrev_b32 v186, 16, v187
    v_and_b32 v187, 0xffff0000, v187
    v_max3_f32 v18, v184, v185, v18
    v_max3_f32 v18, v186, v187, v18
    s_waitcnt vmcnt(7)
    s_cmp_gt_u32 s17, 108
    s_cbranch_scc1 L_x108
    s_waitcnt vmcnt(5)
    s_cmp_gt_u32 s16, 108
    s_cbranch_scc1 L_x108
    s_waitcnt vmcnt(4)
L_x108:
    s_add_u32 m0, s63, 12288
    s_add_u32 s67, s64, 4603904
    buffer_load_dwordx4 v2, s[28:31], s67 offen offset:0 nt lds
    v_mfma_f32_16x16x32_bf16 v[24:27], a[224:227], v[32:35], 0
    v_mfma_f32_16x16x32_bf16 v[24:27], a[228:231], v[36:39], v[24:27]
    v_mfma_f32_16x16x32_bf16 v[24:27], a[232:235], v[40:43], v[24:27]
    v_mfma_f32_16x16x32_bf16 v[24:27], a[236:239], v[44:47], v[24:27]
    v_mfma_f32_16x16x32_bf16 v[24:27], a[240:243], v[48:51], v[24:27]
    v_mfma_f32_16x16x32_bf16 v[24:27], a[244:247], v[52:55], v[24:27]
    v_mfma_f32_16x16x32_bf16 v[24:27], a[248:251], v[56:59], v[24:27]
    v_mfma_f32_16x16x32_bf16 v[24:27], a[252:255], v[60:63], v[24:27]
    s_waitcnt vmcnt(7)
    s_cmp_gt_u32 s17, 109
    s_cbranch_scc1 L_x109
    s_waitcnt vmcnt(5)
    s_cmp_gt_u32 s16, 109
    s_cbranch_scc1 L_x109
    s_waitcnt vmcnt(4)
L_x109:
    buffer_load_dwordx4 v3, s[28:31], s67 offen offset:1024 nt lds
    s_nop 7
    v_cvt_pk_bf16_f32 v189, v24, v25
    v_cvt_pk_bf16_f32 v191, v26, v27
    v_lshlrev_b32 v188, 16, v189
    v_and_b32 v189, 0xffff0000, v189
    v_lshlrev_b32 v190, 16, v191
    v_and_b32 v191, 0xffff0000, v191
    v_max3_f32 v18, v188, v189, v18
    v_max3_f32 v18, v190, v191, v18
    s_waitcnt vmcnt(7)
    s_cmp_gt_u32 s17, 110
    s_cbranch_scc1 L_x110
    s_waitcnt vmcnt(5)
    s_cmp_gt_u32 s16, 110
    s_cbranch_scc1 L_x110
    s_waitcnt vmcnt(4)
L_x110:
    s_add_u32 s67, s64, 4610048
    buffer_load_dwordx4 v4, s[28:31], s67 offen offset:2048 nt lds
    s_waitcnt vmcnt(7)
    s_cmp_gt_u32 s17, 111
    s_cbranch_scc1 L_x111
    s_waitcnt vmcnt(5)
    s_cmp_gt_u32 s16, 111
    s_cbranch_scc1 L_x111
    s_waitcnt vmcnt(4)
L_x111:
    buffer_load_dwordx4 v5, s[28:31], s67 offen offset:3072 nt lds
    v_mov_b32 v255, 1
    s_mov_b64 exec, 1
    ds_add_rtn_u32 v255, v254, v255 offset:12
    s_mov_b64 exec, -1
    ds_read_b64 v[242:243], v254
    ds_read_b128 v[64:67], v6 offset:0
    ds_read_b128 v[68:71], v7 offset:0
    ds_read_b128 v[72:75], v8 offset:0
    ds_read_b128 v[76:79], v9 offset:0
    ds_read_b128 v[80:83], v6 offset:256
    ds_read_b128 v[84:87], v7 offset:256
    ds_read_b128 v[88:91], v8 offset:256
    ds_read_b128 v[92:95], v9 offset:256
    s_waitcnt vmcnt(7)
    s_cmp_gt_u32 s17, 112
    s_cbranch_scc1 L_x112
    s_waitcnt vmcnt(5)
    s_cmp_gt_u32 s16, 112
    s_cbranch_scc1 L_x112
    s_waitcnt vmcnt(4)
L_x112:
    s_add_u32 m0, s63, 16384
    s_add_u32 s67, s64, 8781824
    buffer_load_dwordx4 v2, s[28:31], s67 offen offset:0 nt lds
    s_waitcnt lgkmcnt(0)
    v_readfirstlane_b32 s16, v242
    v_readfirstlane_b32 s17, v243
    v_readfirstlane_b32 s14, v255
    s_sub_u32 s14, s14, s15
    s_cmp_eq_u32 s14, 0
    s_cbranch_scc0 L_ra1_12
    s_mov_b32 s18, 1
    s_atomic_add s18, s[22:23], 34816 glc
L_ra1_12:
    v_mfma_f32_16x16x32_bf16 v[24:27], v[64:67], v[32:35], 0
    v_mfma_f32_16x16x32_bf16 v[24:27], v[68:71], v[36:39], v[24:27]
    v_mfma_f32_16x16x32_bf16 v[24:27], v[72:75], v[40:43], v[24:27]
    v_mfma_f32_16x16x32_bf16 v[24:27], v[76:79], v[44:47], v[24:27]
    v_mfma_f32_16x16x32_bf16 v[24:27], v[80:83], v[48:51], v[24:27]
    v_mfma_f32_16x16x32_bf16 v[24:27], v[84:87], v[52:55], v[24:27]
    v_mfma_f32_16x16x32_bf16 v[24:27], v[88:91], v[56:59], v[24:27]
    v_mfma_f32_16x16x32_bf16 v[24:27], v[92:95], v[60:63], v[24:27]
    s_waitcnt vmcnt(7)
    s_cmp_gt_u32 s17, 113
    s_cbranch_scc1 L_x113
    s_waitcnt vmcnt(5)
    s_cmp_gt_u32 s16, 113
    s_cbranch_scc1 L_x113
    s_waitcnt vmcnt(4)
L_x113:
    buffer_load_dwordx4 v3, s[28:31], s67 offen offset:1024 nt lds
    s_nop 7
    v_cvt_pk_bf16_f32 v209, v24, v25
    v_cvt_pk_bf16_f32 v211, v26, v27
    v_lshlrev_b32 v208, 16, v209
    v_and_b32 v209, 0xffff0000, v209
    v_lshlrev_b32 v210, 16, v211
    v_and_b32 v211, 0xffff0000, v211
    v_max3_f32 v18, v208, v209, v18
    v_max3_f32 v18, v210, v211, v18
    s_waitcnt vmcnt(7)
    s_cmp_gt_u32 s17, 114
    s_cbranch_scc1 L_x114
    s_waitcnt vmcnt(5)
    s_cmp_gt_u32 s16, 114
    s_cbranch_scc1 L_x114
    s_waitcnt vmcnt(4)
L_x114:
    s_add_u32 s67, s64, 8787968
    buffer_load_dwordx4 v4, s[28:31], s67 offen offset:2048 nt lds
    s_waitcnt vmcnt(7)
    s_cmp_gt_u32 s17, 115
    s_cbranch_scc1 L_x115
    s_waitcnt vmcnt(5)
    s_cmp_gt_u32 s16, 115
    s_cbranch_scc1 L_x115
    s_waitcnt vmcnt(4)
L_x115:
    buffer_load_dwordx4 v5, s[28:31], s67 offen offset:3072 nt lds
    s_waitcnt vmcnt(7)
    s_cmp_gt_u32 s17, 116
    s_cbranch_scc1 L_x116
    s_waitcnt vmcnt(5)
    s_cmp_gt_u32 s16, 116
    s_cbranch_scc1 L_x116
    s_waitcnt vmcnt(4)
L_x116:
    s_add_u32 m0, s63, 20480
    s_add_u32 s67, s64, 8798208
    buffer_load_dwordx4 v2, s[28:31], s67 offen offset:0 nt lds
    s_waitcnt vmcnt(7)
    s_cmp_gt_u32 s17, 117
    s_cbranch_scc1 L_x117
    s_waitcnt vmcnt(5)
    s_cmp_gt_u32 s16, 117
    s_cbranch_scc1 L_x117
    s_waitcnt vmcnt(4)
L_x117:
    buffer_load_dwordx4 v3, s[28:31], s67 offen offset:1024 nt lds
    s_waitcnt vmcnt(7)
    s_cmp_gt_u32 s17, 118
    s_cbranch_scc1 L_x118
    s_waitcnt vmcnt(5)
    s_cmp_gt_u32 s16, 118
    s_cbranch_scc1 L_x118
    s_waitcnt vmcnt(4)
L_x118:
    s_add_u32 s67, s64, 8804352
    buffer_load_dwordx4 v4, s[28:31], s67 offen offset:2048 nt lds
    s_waitcnt vmcnt(7)
    s_cmp_gt_u32 s17, 119
    s_cbranch_scc1 L_x119
    s_waitcnt vmcnt(5)
    s_cmp_gt_u32 s16, 119
    s_cbranch_scc1 L_x119
    s_waitcnt vmcnt(4)
L_x119:
    buffer_load_dwordx4 v5, s[28:31], s67 offen offset:3072 nt lds
    ds_read_b64 v[242:243], v254
    ds_read_b128 v[64:67], v6 offset:8192
    ds_read_b128 v[68:71], v7 offset:8192
    ds_read_b128 v[72:75], v8 offset:8192
    ds_read_b128 v[76:79], v9 offset:8192
    ds_read_b128 v[80:83], v6 offset:8448
    ds_read_b128 v[84:87], v7 offset:8448
    ds_read_b128 v[88:91], v8 offset:8448
    ds_read_b128 v[92:95], v9 offset:8448
    s_waitcnt vmcnt(7)
    s_cmp_gt_u32 s17, 120
    s_cbranch_scc1 L_x120
    s_waitcnt vmcnt(5)
    s_cmp_gt_u32 s16, 120
    s_cbranch_scc1 L_x120
    s_waitcnt vmcnt(4)
L_x120:
    s_add_u32 m0, s63, 0
    s_add_u32 s67, s64, 12976128
    buffer_load_dwordx4 v2, s[28:31], s67 offen offset:0 nt lds
    s_waitcnt lgkmcnt(0)
    v_readfirstlane_b32 s16, v242
    v_readfirstlane_b32 s17, v243
    s_cmp_eq_u32 s14, 0
    s_cbranch_scc0 L_rkd1_0
    s_sub_u32 s16, s18, 16
    s_mul_i32 s16, s16, 8
    s_add_u32 s16, s16, 125
    s_cmp_gt_u32 s18, 16
    s_cselect_b32 s16, s16, 0
    s_sub_u32 s17, s18, 26
    s_mul_i32 s17, s17, 8
    s_add_u32 s17, s17, 125
    s_cmp_gt_u32 s18, 26
    s_cselect_b32 s17, s17, 0
    v_mov_b32 v242, s16
    v_mov_b32 v243, s17
    ds_write_b64 v254, v[242:243]
L_rkd1_0:
    v_mfma_f32_16x16x32_bf16 v[24:27], v[64:67], v[32:35], 0
    v_mfma_f32_16x16x32_bf16 v[24:27], v[68:71], v[36:39], v[24:27]
    v_mfma_f32_16x16x32_bf16 v[24:27], v[72:75], v[40:43], v[24:27]
    v_mfma_f32_16x16x32_bf16 v[24:27], v[76:79], v[44:47], v[24:27]
    v_mfma_f32_16x16x32_bf16 v[24:27], v[80:83], v[48:51], v[24:27]
    v_mfma_f32_16x16x32_bf16 v[24:27], v[84:87], v[52:55], v[24:27]
    v_mfma_f32_16x16x32_bf16 v[24:27], v[88:91], v[56:59], v[24:27]
    v_mfma_f32_16x16x32_bf16 v[24:27], v[92:95], v[60:63], v[24:27]
    s_waitcnt vmcnt(7)
    s_cmp_gt_u32 s17, 121
    s_cbranch_scc1 L_x121
    s_waitcnt vmcnt(5)
    s_cmp_gt_u32 s16, 121
    s_cbranch_scc1 L_x121
    s_waitcnt vmcnt(4)
L_x121:
    buffer_load_dwordx4 v3, s[28:31], s67 offen offset:1024 nt lds
    s_nop 7
    v_cvt_pk_bf16_f32 v213, v24, v25
    v_cvt_pk_bf16_f32 v215, v26, v27
    v_lshlrev_b32 v212, 16, v213
    v_and_b32 v213, 0xffff0000, v213
    v_lshlrev_b32 v214, 16, v215
    v_and_b32 v215, 0xffff0000, v215
    v_max3_f32 v18, v212, v213, v18
    v_max3_f32 v18, v214, v215, v18
    s_waitcnt vmcnt(7)
    s_cmp_gt_u32 s17, 122
    s_cbranch_scc1 L_x122
    s_waitcnt vmcnt(5)
    s_cmp_gt_u32 s16, 122
    s_cbranch_scc1 L_x122
    s_waitcnt vmcnt(4)
L_x122:
    s_add_u32 s67, s64, 12982272
    buffer_load_dwordx4 v4, s[28:31], s67 offen offset:2048 nt lds
    s_waitcnt vmcnt(7)
    s_cmp_gt_u32 s17, 123
    s_cbranch_scc1 L_x123
    s_waitcnt vmcnt(5)
    s_cmp_gt_u32 s16, 123
    s_cbranch_scc1 L_x123
    s_waitcnt vmcnt(4)
L_x123:
    buffer_load_dwordx4 v5, s[28:31], s67 offen offset:3072 nt lds
    s_waitcnt vmcnt(7)
    s_cmp_gt_u32 s17, 124
    s_cbranch_scc1 L_x124
    s_waitcnt vmcnt(5)
    s_cmp_gt_u32 s16, 124
    s_cbranch_scc1 L_x124
    s_waitcnt vmcnt(4)
L_x124:
    s_add_u32 m0, s63, 4096
    s_add_u32 s67, s64, 12992512
    buffer_load_dwordx4 v2, s[28:31], s67 offen offset:0 nt lds
    s_waitcnt vmcnt(7)
    s_cmp_gt_u32 s17, 125
    s_cbranch_scc1 L_x125
    s_waitcnt vmcnt(5)
    s_cmp_gt_u32 s16, 125
    s_cbranch_scc1 L_x125
    s_waitcnt vmcnt(4)
L_x125:
    buffer_load_dwordx4 v3, s[28:31], s67 offen offset:1024 nt lds
    s_waitcnt vmcnt(7)
    s_cmp_gt_u32 s17, 126
    s_cbranch_scc1 L_x126
    s_waitcnt vmcnt(5)
    s_cmp_gt_u32 s16, 126
    s_cbranch_scc1 L_x126
    s_waitcnt vmcnt(4)
L_x126:
    s_add_u32 s67, s64, 12998656
    buffer_load_dwordx4 v4, s[28:31], s67 offen offset:2048 nt lds
    s_waitcnt vmcnt(7)
    s_cmp_gt_u32 s17, 127
    s_cbranch_scc1 L_x127
    s_waitcnt vmcnt(5)
    s_cmp_gt_u32 s16, 127
    s_cbranch_scc1 L_x127
    s_waitcnt vmcnt(4)
L_x127:
    buffer_load_dwordx4 v5, s[28:31], s67 offen offset:3072 nt lds
    ds_read_b64 v[242:243], v254
    ds_read_b128 v[64:67], v6 offset:16384
    ds_read_b128 v[68:71], v7 offset:16384
    ds_read_b128 v[72:75], v8 offset:16384
    ds_read_b128 v[76:79], v9 offset:16384
    ds_read_b128 v[80:83], v6 offset:16640
    ds_read_b128 v[84:87], v7 offset:16640
    ds_read_b128 v[88:91], v8 offset:16640
    ds_read_b128 v[92:95], v9 offset:16640
    s_waitcnt vmcnt(7)
    s_cmp_gt_u32 s17, 128
    s_cbranch_scc1 L_x128
    s_waitcnt vmcnt(5)
    s_cmp_gt_u32 s16, 128
    s_cbranch_scc1 L_x128
    s_waitcnt vmcnt(4)
L_x128:
    s_add_u32 m0, s63, 8192
    s_add_u32 s67, s64, 0
    buffer_load_dwordx4 v2, s[32:35], s67 offen offset:0 nt lds
    s_waitcnt lgkmcnt(0)
    v_readfirstlane_b32 s16, v242
    v_readfirstlane_b32 s17, v243
    v_mfma_f32_16x16x32_bf16 v[24:27], v[64:67], v[32:35], 0
    v_mfma_f32_16x16x32_bf16 v[24:27], v[68:71], v[36:39], v[24:27]
    v_mfma_f32_16x16x32_bf16 v[24:27], v[72:75], v[40:43], v[24:27]
    v_mfma_f32_16x16x32_bf16 v[24:27], v[76:79], v[44:47], v[24:27]
    v_mfma_f32_16x16x32_bf16 v[24:27], v[80:83], v[48:51], v[24:27]
    v_mfma_f32_16x16x32_bf16 v[24:27], v[84:87], v[52:55], v[24:27]
    v_mfma_f32_16x16x32_bf16 v[24:27], v[88:91], v[56:59], v[24:27]
    v_mfma_f32_16x16x32_bf16 v[24:27], v[92:95], v[60:63], v[24:27]
    s_waitcnt vmcnt(7)
    s_cmp_gt_u32 s17, 129
    s_cbranch_scc1 L_x129
    s_waitcnt vmcnt(5)
    s_cmp_gt_u32 s16, 129
    s_cbranch_scc1 L_x129
    s_waitcnt vmcnt(4)
L_x129:
    buffer_load_dwordx4 v3, s[32:35], s67 offen offset:1024 nt lds
    s_nop 7
    v_cvt_pk_bf16_f32 v217, v24, v25
    v_cvt_pk_bf16_f32 v219, v26, v27
    v_lshlrev_b32 v216, 16, v217
    v_and_b32 v217, 0xffff0000, v217
    v_lshlrev_b32 v218, 16, v219
    v_and_b32 v219, 0xffff0000, v219
    v_max3_f32 v18, v216, v217, v18
    v_max3_f32 v18, v218, v219, v18
    s_waitcnt vmcnt(7)
    s_cmp_gt_u32 s17, 130
    s_cbranch_scc1 L_x130
    s_waitcnt vmcnt(5)
    s_cmp_gt_u32 s16, 130
    s_cbranch_scc1 L_x130
    s_waitcnt vmcnt(4)
L_x130:
    s_add_u32 s67, s64, 6144
    buffer_load_dwordx4 v4, s[32:35], s67 offen offset:2048 nt lds
    s_waitcnt vmcnt(7)
    s_cmp_gt_u32 s17, 131
    s_cbranch_scc1 L_x131
    s_waitcnt vmcnt(5)
    s_cmp_gt_u32 s16, 131
    s_cbranch_scc1 L_x131
    s_waitcnt vmcnt(4)
L_x131:
    buffer_load_dwordx4 v5, s[32:35], s67 offen offset:3072 nt lds
    s_waitcnt vmcnt(7)
    s_cmp_gt_u32 s17, 132
    s_cbranch_scc1 L_x132
    s_waitcnt vmcnt(5)
    s_cmp_gt_u32 s16, 132
    s_cbranch_scc1 L_x132
    s_waitcnt vmcnt(4)
L_x132:
    s_add_u32 m0, s63, 12288
    s_add_u32 s67, s64, 16384
    buffer_load_dwordx4 v2, s[32:35], s67 offen offset:0 nt lds
    s_waitcnt vmcnt(7)
    s_cmp_gt_u32 s17, 133
    s_cbranch_scc1 L_x133
    s_waitcnt vmcnt(5)
    s_cmp_gt_u32 s16, 133
    s_cbranch_scc1 L_x133
    s_waitcnt vmcnt(4)
L_x133:
    buffer_load_dwordx4 v3, s[32:35], s67 offen offset:1024 nt lds
    s_waitcnt vmcnt(7)
    s_cmp_gt_u32 s17, 134
    s_cbranch_scc1 L_x134
    s_waitcnt vmcnt(5)
    s_cmp_gt_u32 s16, 134
    s_cbranch_scc1 L_x134
    s_waitcnt vmcnt(4)
L_x134:
    s_add_u32 s67, s64, 22528
    buffer_load_dwordx4 v4, s[32:35], s67 offen offset:2048 nt lds
    s_waitcnt vmcnt(7)
    s_cmp_gt_u32 s17, 135
    s_cbranch_scc1 L_x135
    s_waitcnt vmcnt(5)
    s_cmp_gt_u32 s16, 135
    s_cbranch_scc1 L_x135
    s_waitcnt vmcnt(4)
L_x135:
    buffer_load_dwordx4 v5, s[32:35], s67 offen offset:3072 nt lds
    ds_read_b64 v[242:243], v254
    ds_read_b128 v[64:67], v6 offset:0
    ds_read_b128 v[68:71], v7 offset:0
    ds_read_b128 v[72:75], v8 offset:0
    ds_read_b128 v[76:79], v9 offset:0
    ds_read_b128 v[80:83], v6 offset:256
    ds_read_b128 v[84:87], v7 offset:256
    ds_read_b128 v[88:91], v8 offset:256
    ds_read_b128 v[92:95], v9 offset:256
    s_waitcnt vmcnt(7)
    s_cmp_gt_u32 s17, 136
    s_cbranch_scc1 L_x136
    s_waitcnt vmcnt(5)
    s_cmp_gt_u32 s16, 136
    s_cbranch_scc1 L_x136
    s_waitcnt vmcnt(4)
L_x136:
    s_add_u32 m0, s63, 16384
    s_add_u32 s67, s64, 4194304
    buffer_load_dwordx4 v2, s[32:35], s67 offen offset:0 nt lds
    s_waitcnt lgkmcnt(0)
    v_readfirstlane_b32 s16, v242
    v_readfirstlane_b32 s17, v243
    v_mfma_f32_16x16x32_bf16 v[24:27], v[64:67], v[32:35], 0
    v_mfma_f32_16x16x32_bf16 v[24:27], v[68:71], v[36:39], v[24:27]
    v_mfma_f32_16x16x32_bf16 v[24:27], v[72:75], v[40:43], v[24:27]
    v_mfma_f32_16x16x32_bf16 v[24:27], v[76:79], v[44:47], v[24:27]
    v_mfma_f32_16x16x32_bf16 v[24:27], v[80:83], v[48:51], v[24:27]
    v_mfma_f32_16x16x32_bf16 v[24:27], v[84:87], v[52:55], v[24:27]
    v_mfma_f32_16x16x32_bf16 v[24:27], v[88:91], v[56:59], v[24:27]
    v_mfma_f32_16x16x32_bf16 v[24:27], v[92:95], v[60:63], v[24:27]
    s_waitcnt vmcnt(7)
    s_cmp_gt_u32 s17, 137
    s_cbranch_scc1 L_x137
    s_waitcnt vmcnt(5)
    s_cmp_gt_u32 s16, 137
    s_cbranch_scc1 L_x137
    s_waitcnt vmcnt(4)
L_x137:
    buffer_load_dwordx4 v3, s[32:35], s67 offen offset:1024 nt lds
    s_nop 7
    v_cvt_pk_bf16_f32 v221, v24, v25
    v_cvt_pk_bf16_f32 v223, v26, v27
    v_lshlrev_b32 v220, 16, v221
    v_and_b32 v221, 0xffff0000, v221
    v_lshlrev_b32 v222, 16, v223
    v_and_b32 v223, 0xffff0000, v223
    v_max3_f32 v18, v220, v221, v18
    v_max3_f32 v18, v222, v223, v18
    s_waitcnt vmcnt(7)
    s_cmp_gt_u32 s17, 138
    s_cbranch_scc1 L_x138
    s_waitcnt vmcnt(5)
    s_cmp_gt_u32 s16, 138
    s_cbranch_scc1 L_x138
    s_waitcnt vmcnt(4)
L_x138:
    s_add_u32 s67, s64, 4200448
    buffer_load_dwordx4 v4, s[32:35], s67 offen offset:2048 nt lds
    s_getreg_b32 s83, hwreg(HW_REG_XCC_ID, 0, 4)
    v_mov_b32 v224, v18
    s_nop 1
    v_permlane16_swap_b32 v18, v224
    s_nop 0
    v_max_f32 v18, v18, v224
    v_mov_b32 v224, v18
    s_nop 1
    v_permlane32_swap_b32 v18, v224
    s_nop 0
    v_max_f32 v18, v18, v224
    v_mul_f32 v19, s65, v18
    v_mov_b32 v24, 0
    v_mov_b32 v25, 0
    s_waitcnt vmcnt(7)
    s_cmp_gt_u32 s17, 139
    s_cbranch_scc1 L_x139
    s_waitcnt vmcnt(5)
    s_cmp_gt_u32 s16, 139
    s_cbranch_scc1 L_x139
    s_waitcnt vmcnt(4)
L_x139:
    buffer_load_dwordx4 v5, s[32:35], s67 offen offset:3072 nt lds
    v_fma_f32 v28, v160, s65, -v19
    v_fma_f32 v29, v161, s65, -v19
    v_fma_f32 v30, v162, s65, -v19
    v_fma_f32 v31, v163, s65, -v19
    v_exp_f32 v28, v28
    v_exp_f32 v29, v29
    v_exp_f32 v30, v30
    v_exp_f32 v31, v31
    s_nop 0
    v_cvt_pk_bf16_f32 v20, v28, v29
    v_cvt_pk_bf16_f32 v21, v30, v31
    s_waitcnt vmcnt(7)
    s_cmp_gt_u32 s17, 140
    s_cbranch_scc1 L_x140
    s_waitcnt vmcnt(5)
    s_cmp_gt_u32 s16, 140
    s_cbranch_scc1 L_x140
    s_waitcnt vmcnt(4)
L_x140:
    s_add_u32 m0, s63, 20480
    s_add_u32 s67, s64, 4210688
    buffer_load_dwordx4 v2, s[32:35], s67 offen offset:0 nt lds
    s_waitcnt vmcnt(7)
    s_cmp_gt_u32 s17, 141
    s_cbranch_scc1 L_x141
    s_waitcnt vmcnt(5)
    s_cmp_gt_u32 s16, 141
    s_cbranch_scc1 L_x141
    s_waitcnt vmcnt(4)
L_x141:
    buffer_load_dwordx4 v3, s[32:35], s67 offen offset:1024 nt lds
    s_waitcnt vmcnt(7)
    s_cmp_gt_u32 s17, 142
    s_cbranch_scc1 L_x142
    s_waitcnt vmcnt(5)
    s_cmp_gt_u32 s16, 142
    s_cbranch_scc1 L_x142
    s_waitcnt vmcnt(4)
L_x142:
    s_add_u32 s67, s64, 4216832
    buffer_load_dwordx4 v4, s[32:35], s67 offen offset:2048 nt lds
    s_waitcnt vmcnt(7)
    s_cmp_gt_u32 s17, 143
    s_cbranch_scc1 L_x143
    s_waitcnt vmcnt(5)
    s_cmp_gt_u32 s16, 143
    s_cbranch_scc1 L_x143
    s_waitcnt vmcnt(4)
L_x143:
    buffer_load_dwordx4 v5, s[32:35], s67 offen offset:3072 nt lds
    v_mov_b32 v255, 1
    s_mov_b64 exec, 1
    ds_add_rtn_u32 v255, v254, v255 offset:16
    s_mov_b64 exec, -1
    ds_read_b64 v[242:243], v254
    ds_read_b64_tr_b16 v[32:33], v10 offset:8192
    ds_read_b64_tr_b16 v[34:35], v10 offset:8320
    ds_read_b64_tr_b16 v[36:37], v10 offset:8448
    ds_read_b64_tr_b16 v[38:39], v10 offset:8576
    ds_read_b64_tr_b16 v[40:41], v10 offset:10368
    ds_read_b64_tr_b16 v[42:43], v10 offset:10240
    ds_read_b64_tr_b16 v[44:45], v10 offset:10624
    ds_read_b64_tr_b16 v[46:47], v10 offset:10496
    ds_read_b64_tr_b16 v[48:49], v10 offset:12288
    ds_read_b64_tr_b16 v[50:51], v10 offset:12416
    ds_read_b64_tr_b16 v[52:53], v10 offset:12544
    ds_read_b64_tr_b16 v[54:55], v10 offset:12672
    ds_read_b64_tr_b16 v[56:57], v10 offset:14464
    ds_read_b64_tr_b16 v[58:59], v10 offset:14336
    ds_read_b64_tr_b16 v[60:61], v10 offset:14720
    ds_read_b64_tr_b16 v[62:63], v10 offset:14592
    s_waitcnt vmcnt(7)
    s_cmp_gt_u32 s17, 144
    s_cbranch_scc1 L_x144
    s_waitcnt vmcnt(5)
    s_cmp_gt_u32 s16, 144
    s_cbranch_scc1 L_x144
    s_waitcnt vmcnt(4)
L_x144:
    s_add_u32 m0, s63, 0
    s_add_u32 s67, s64, 8388608
    buffer_load_dwordx4 v2, s[32:35], s67 offen offset:0 nt lds
    s_waitcnt lgkmcnt(0)
    v_readfirstlane_b32 s16, v242
    v_readfirstlane_b32 s17, v243
    v_readfirstlane_b32 s14, v255
    s_sub_u32 s14, s14, s15
    s_cmp_eq_u32 s14, 0
    s_cbranch_scc0 L_ra2_16
    s_mov_b32 s18, 1
    s_atomic_add s18, s[22:23], 69632 glc
L_ra2_16:
    v_mfma_f32_4x4x4_16b_bf16 v[96:99], v[20:21], v[32:33], 0 cbsz:4 abid:0
    v_mfma_f32_4x4x4_16b_bf16 v[100:103], v[20:21], v[34:35], 0 cbsz:4 abid:0
    v_mfma_f32_4x4x4_16b_bf16 v[104:107], v[20:21], v[36:37], 0 cbsz:4 abid:0
    v_mfma_f32_4x4x4_16b_bf16 v[108:111], v[20:21], v[38:39], 0 cbsz:4 abid:0
    v_mfma_f32_4x4x4_16b_bf16 v[96:99], v[20:21], v[40:41], v[96:99] cbsz:4 abid:4
    v_mfma_f32_4x4x4_16b_bf16 v[100:103], v[20:21], v[42:43], v[100:103] cbsz:4 abid:4
    v_mfma_f32_4x4x4_16b_bf16 v[104:107], v[20:21], v[44:45], v[104:107] cbsz:4 abid:4
    v_mfma_f32_4x4x4_16b_bf16 v[108:111], v[20:21], v[46:47], v[108:111] cbsz:4 abid:4
    v_mfma_f32_4x4x4_16b_bf16 v[96:99], v[20:21], v[48:49], v[96:99] cbsz:4 abid:8
    v_mfma_f32_4x4x4_16b_bf16 v[100:103], v[20:21], v[50:51], v[100:103] cbsz:4 abid:8
    v_mfma_f32_4x4x4_16b_bf16 v[104:107], v[20:21], v[52:53], v[104:107] cbsz:4 abid:8
    v_mfma_f32_4x4x4_16b_bf16 v[108:111], v[20:21], v[54:55], v[108:111] cbsz:4 abid:8
    v_mfma_f32_4x4x4_16b_bf16 v[96:99], v[20:21], v[56:57], v[96:99] cbsz:4 abid:12
    v_mfma_f32_4x4x4_16b_bf16 v[100:103], v[20:21], v[58:59], v[100:103] cbsz:4 abid:12
    v_mfma_f32_4x4x4_16b_bf16 v[104:107], v[20:21], v[60:61], v[104:107] cbsz:4 abid:12
    v_mfma_f32_4x4x4_16b_bf16 v[108:111], v[20:21], v[62:63], v[108:111] cbsz:4 abid:12
    s_waitcnt vmcnt(7)
    s_cmp_gt_u32 s17, 145
    s_cbranch_scc1 L_x145
    s_waitcnt vmcnt(5)
    s_cmp_gt_u32 s16, 145
    s_cbranch_scc1 L_x145
    s_waitcnt vmcnt(4)
L_x145:
    buffer_load_dwordx4 v3, s[32:35], s67 offen offset:1024 nt lds
    v_fma_f32 v28, v160, s65, -v19
    v_fma_f32 v29, v161, s65, -v19
    v_fma_f32 v30, v162, s65, -v19
    v_fma_f32 v31, v163, s65, -v19
    v_exp_f32 v28, v28
    v_exp_f32 v29, v29
    v_exp_f32 v30, v30
    v_exp_f32 v31, v31
    s_nop 0
    v_add_f32 v24, v24, v28
    v_add_f32 v25, v25, v29
    v_add_f32 v24, v24, v30
    v_add_f32 v25, v25, v31
    v_fma_f32 v28, v164, s65, -v19
    v_fma_f32 v29, v165, s65, -v19
    v_fma_f32 v30, v166, s65, -v19
    v_fma_f32 v31, v167, s65, -v19
    v_exp_f32 v28, v28
    v_exp_f32 v29, v29
    v_exp_f32 v30, v30
    v_exp_f32 v31, v31
    s_nop 0
    v_add_f32 v24, v24, v28
    v_add_f32 v25, v25, v29
    v_add_f32 v24, v24, v30
    v_add_f32 v25, v25, v31
    s_waitcnt vmcnt(7)
    s_cmp_gt_u32 s17, 146
    s_cbranch_scc1 L_x146
    s_waitcnt vmcnt(5)
    s_cmp_gt_u32 s16, 146
    s_cbranch_scc1 L_x146
    s_waitcnt vmcnt(4)
L_x146:
    s_add_u32 s67, s64, 8394752
    buffer_load_dwordx4 v4, s[32:35], s67 offen offset:2048 nt lds
    v_fma_f32 v28, v168, s65, -v19
    v_fma_f32 v29, v169, s65, -v19
    v_fma_f32 v30, v170, s65, -v19
    v_fma_f32 v31, v171, s65, -v19
    v_exp_f32 v28, v28
    v_exp_f32 v29, v29
    v_exp_f32 v30, v30
    v_exp_f32 v31, v31
    s_nop 0
    v_add_f32 v24, v24, v28
    v_add_f32 v25, v25, v29
    v_add_f32 v24, v24, v30
    v_add_f32 v25, v25, v31
    v_fma_f32 v28, v172, s65, -v19
    v_fma_f32 v29, v173, s65, -v19
    v_fma_f32 v30, v174, s65, -v19
    v_fma_f32 v31, v175, s65, -v19
    v_exp_f32 v28, v28
    v_exp_f32 v29, v29
    v_exp_f32 v30, v30
    v_exp_f32 v31, v31
    s_nop 0
    v_add_f32 v24, v24, v28
    v_add_f32 v25, v25, v29
    v_add_f32 v24, v24, v30
    v_add_f32 v25, v25, v31
    s_waitcnt vmcnt(7)
    s_cmp_gt_u32 s17, 147
    s_cbranch_scc1 L_x147
    s_waitcnt vmcnt(5)
    s_cmp_gt_u32 s16, 147
    s_cbranch_scc1 L_x147
    s_waitcnt vmcnt(4)
L_x147:
    buffer_load_dwordx4 v5, s[32:35], s67 offen offset:3072 nt lds
    v_fma_f32 v28, v176, s65, -v19
    v_fma_f32 v29, v177, s65, -v19
    v_fma_f32 v30, v178, s65, -v19
    v_fma_f32 v31, v179, s65, -v19
    v_exp_f32 v28, v28
    v_exp_f32 v29, v29
    v_exp_f32 v30, v30
    v_exp_f32 v31, v31
    s_nop 0
    v_add_f32 v24, v24, v28
    v_add_f32 v25, v25, v29
    v_add_f32 v24, v24, v30
    v_add_f32 v25, v25, v31
    v_fma_f32 v28, v180, s65, -v19
    v_fma_f32 v29, v181, s65, -v19
    v_fma_f32 v30, v182, s65, -v19
    v_fma_f32 v31, v183, s65, -v19
    v_exp_f32 v28, v28
    v_exp_f32 v29, v29
    v_exp_f32 v30, v30
    v_exp_f32 v31, v31
    s_nop 0
    v_add_f32 v24, v24, v28
    v_add_f32 v25, v25, v29
    v_add_f32 v24, v24, v30
    v_add_f32 v25, v25, v31
    s_waitcnt vmcnt(7)
    s_cmp_gt_u32 s17, 148
    s_cbranch_scc1 L_x148
    s_waitcnt vmcnt(5)
    s_cmp_gt_u32 s16, 148
    s_cbranch_scc1 L_x148
    s_waitcnt vmcnt(4)
L_x148:
    s_add_u32 m0, s63, 4096
    s_add_u32 s67, s64, 8404992
    buffer_load_dwordx4 v2, s[32:35], s67 offen offset:0 nt lds
    v_fma_f32 v28, v164, s65, -v19
    v_fma_f32 v29, v165, s65, -v19
    v_fma_f32 v30, v166, s65, -v19
    v_fma_f32 v31, v167, s65, -v19
    v_exp_f32 v28, v28
    v_exp_f32 v29, v29
    v_exp_f32 v30, v30
    v_exp_f32 v31, v31
    s_nop 0
    v_cvt_pk_bf16_f32 v22, v28, v29
    v_cvt_pk_bf16_f32 v23, v30, v31
    s_waitcnt vmcnt(7)
    s_cmp_gt_u32 s17, 149
    s_cbranch_scc1 L_x149
    s_waitcnt vmcnt(5)
    s_cmp_gt_u32 s16, 149
    s_cbranch_scc1 L_x149
    s_waitcnt vmcnt(4)
L_x149:
    buffer_load_dwordx4 v3, s[32:35], s67 offen offset:1024 nt lds
    s_waitcnt vmcnt(7)
    s_cmp_gt_u32 s17, 150
    s_cbranch_scc1 L_x150
    s_waitcnt vmcnt(5)
    s_cmp_gt_u32 s16, 150
    s_cbranch_scc1 L_x150
    s_waitcnt vmcnt(4)
L_x150:
    s_add_u32 s67, s64, 8411136
    buffer_load_dwordx4 v4, s[32:35], s67 offen offset:2048 nt lds
    s_waitcnt vmcnt(7)
    s_cmp_gt_u32 s17, 151
    s_cbranch_scc1 L_x151
    s_waitcnt vmcnt(5)
    s_cmp_gt_u32 s16, 151
    s_cbranch_scc1 L_x151
    s_waitcnt vmcnt(4)
L_x151:
    buffer_load_dwordx4 v5, s[32:35], s67 offen offset:3072 nt lds
    ds_read_b64 v[242:243], v254
    ds_read_b64_tr_b16 v[32:33], v10 offset:16384
    ds_read_b64_tr_b16 v[34:35], v10 offset:16512
    ds_read_b64_tr_b16 v[36:37], v10 offset:16640
    ds_read_b64_tr_b16 v[38:39], v10 offset:16768
    ds_read_b64_tr_b16 v[40:41], v10 offset:18560
    ds_read_b64_tr_b16 v[42:43], v10 offset:18432
    ds_read_b64_tr_b16 v[44:45], v10 offset:18816
    ds_read_b64_tr_b16 v[46:47], v10 offset:18688
    ds_read_b64_tr_b16 v[48:49], v10 offset:20480
    ds_read_b64_tr_b16 v[50:51], v10 offset:20608
    ds_read_b64_tr_b16 v[52:53], v10 offset:20736
    ds_read_b64_tr_b16 v[54:55], v10 offset:20864
    ds_read_b64_tr_b16 v[56:57], v10 offset:22656
    ds_read_b64_tr_b16 v[58:59], v10 offset:22528
    ds_read_b64_tr_b16 v[60:61], v10 offset:22912
    ds_read_b64_tr_b16 v[62:63], v10 offset:22784
    s_waitcnt vmcnt(7)
    s_cmp_gt_u32 s17, 152
    s_cbranch_scc1 L_x152
    s_waitcnt vmcnt(5)
    s_cmp_gt_u32 s16, 152
    s_cbranch_scc1 L_x152
    s_waitcnt vmcnt(4)
L_x152:
    s_add_u32 m0, s63, 8192
    s_add_u32 s67, s64, 12582912
    buffer_load_dwordx4 v2, s[32:35], s67 offen offset:0 nt lds
    s_waitcnt lgkmcnt(0)
    v_readfirstlane_b32 s16, v242
    v_readfirstlane_b32 s17, v243
    s_cmp_eq_u32 s14, 0
    s_cbranch_scc0 L_rkd2_0
    s_sub_u32 s16, s18, 18
    s_mul_i32 s16, s16, 8
    s_add_u32 s16, s16, 157
    s_cmp_gt_u32 s18, 18
    s_cselect_b32 s16, s16, 0
    s_sub_u32 s17, s18, 26
    s_mul_i32 s17, s17, 8
    s_add_u32 s17, s17, 157
    s_cmp_gt_u32 s18, 26
    s_cselect_b32 s17, s17, 0
    v_mov_b32 v242, s16
    v_mov_b32 v243, s17
    ds_write_b64 v254, v[242:243]
L_rkd2_0:
    v_mfma_f32_4x4x4_16b_bf16 v[96:99], v[22:23], v[32:33], v[96:99] cbsz:4 abid:0
    v_mfma_f32_4x4x4_16b_bf16 v[100:103], v[22:23], v[34:35], v[100:103] cbsz:4 abid:0
    v_mfma_f32_4x4x4_16b_bf16 v[104:107], v[22:23], v[36:37], v[104:107] cbsz:4 abid:0
    v_mfma_f32_4x4x4_16b_bf16 v[108:111], v[22:23], v[38:39], v[108:111] cbsz:4 abid:0
    v_mfma_f32_4x4x4_16b_bf16 v[96:99], v[22:23], v[40:41], v[96:99] cbsz:4 abid:4
    v_mfma_f32_4x4x4_16b_bf16 v[100:103], v[22:23], v[42:43], v[100:103] cbsz:4 abid:4
    v_mfma_f32_4x4x4_16b_bf16 v[104:107], v[22:23], v[44:45], v[104:107] cbsz:4 abid:4
    v_mfma_f32_4x4x4_16b_bf16 v[108:111], v[22:23], v[46:47], v[108:111] cbsz:4 abid:4
    v_mfma_f32_4x4x4_16b_bf16 v[96:99], v[22:23], v[48:49], v[96:99] cbsz:4 abid:8
    v_mfma_f32_4x4x4_16b_bf16 v[100:103], v[22:23], v[50:51], v[100:103] cbsz:4 abid:8
    v_mfma_f32_4x4x4_16b_bf16 v[104:107], v[22:23], v[52:53], v[104:107] cbsz:4 abid:8
    v_mfma_f32_4x4x4_16b_bf16 v[108:111], v[22:23], v[54:55], v[108:111] cbsz:4 abid:8
    v_mfma_f32_4x4x4_16b_bf16 v[96:99], v[22:23], v[56:57], v[96:99] cbsz:4 abid:12
    v_mfma_f32_4x4x4_16b_bf16 v[100:103], v[22:23], v[58:59], v[100:103] cbsz:4 abid:12
    v_mfma_f32_4x4x4_16b_bf16 v[104:107], v[22:23], v[60:61], v[104:107] cbsz:4 abid:12
    v_mfma_f32_4x4x4_16b_bf16 v[108:111], v[22:23], v[62:63], v[108:111] cbsz:4 abid:12
    s_waitcnt vmcnt(7)
    s_cmp_gt_u32 s17, 153
    s_cbranch_scc1 L_x153
    s_waitcnt vmcnt(5)
    s_cmp_gt_u32 s16, 153
    s_cbranch_scc1 L_x153
    s_waitcnt vmcnt(4)
L_x153:
    buffer_load_dwordx4 v3, s[32:35], s67 offen offset:1024 nt lds
    v_fma_f32 v28, v184, s65, -v19
    v_fma_f32 v29, v185, s65, -v19
    v_fma_f32 v30, v186, s65, -v19
    v_fma_f32 v31, v187, s65, -v19
    v_exp_f32 v28, v28
    v_exp_f32 v29, v29
    v_exp_f32 v30, v30
    v_exp_f32 v31, v31
    s_nop 0
    v_add_f32 v24, v24, v28
    v_add_f32 v25, v25, v29
    v_add_f32 v24, v24, v30
    v_add_f32 v25, v25, v31
    v_fma_f32 v28, v188, s65, -v19
    v_fma_f32 v29, v189, s65, -v19
    v_fma_f32 v30, v190, s65, -v19
    v_fma_f32 v31, v191, s65, -v19
    v_exp_f32 v28, v28
    v_exp_f32 v29, v29
    v_exp_f32 v30, v30
    v_exp_f32 v31, v31
    s_nop 0
    v_add_f32 v24, v24, v28
    v_add_f32 v25, v25, v29
    v_add_f32 v24, v24, v30
    v_add_f32 v25, v25, v31
    s_waitcnt vmcnt(7)
    s_cmp_gt_u32 s17, 154
    s_cbranch_scc1 L_x154
    s_waitcnt vmcnt(5)
    s_cmp_gt_u32 s16, 154
    s_cbranch_scc1 L_x154
    s_waitcnt vmcnt(4)
L_x154:
    s_add_u32 s67, s64, 12589056
    buffer_load_dwordx4 v4, s[32:35], s67 offen offset:2048 nt lds
    v_fma_f32 v28, v192, s65, -v19
    v_fma_f32 v29, v193, s65, -v19
    v_fma_f32 v30, v194, s65, -v19
    v_fma_f32 v31, v195, s65, -v19
    v_exp_f32 v28, v28
    v_exp_f32 v29, v29
    v_exp_f32 v30, v30
    v_exp_f32 v31, v31
    s_nop 0
    v_add_f32 v24, v24, v28
    v_add_f32 v25, v25, v29
    v_add_f32 v24, v24, v30
    v_add_f32 v25, v25, v31
    v_fma_f32 v28, v196, s65, -v19
    v_fma_f32 v29, v197, s65, -v19
    v_fma_f32 v30, v198, s65, -v19
    v_fma_f32 v31, v199, s65, -v19
    v_exp_f32 v28, v28
    v_exp_f32 v29, v29
    v_exp_f32 v30, v30
    v_exp_f32 v31, v31
    s_nop 0
    v_add_f32 v24, v24, v28
    v_add_f32 v25, v25, v29
    v_add_f32 v24, v24, v30
    v_add_f32 v25, v25, v31
    s_waitcnt vmcnt(7)
    s_cmp_gt_u32 s17, 155
    s_cbranch_scc1 L_x155
    s_waitcnt vmcnt(5)
    s_cmp_gt_u32 s16, 155
    s_cbranch_scc1 L_x155
    s_waitcnt vmcnt(4)
L_x155:
    buffer_load_dwordx4 v5, s[32:35], s67 offen offset:3072 nt lds
    v_fma_f32 v28, v168, s65, -v19
    v_fma_f32 v29, v169, s65, -v19
    v_fma_f32 v30, v170, s65, -v19
    v_fma_f32 v31, v171, s65, -v19
    v_exp_f32 v28, v28
    v_exp_f32 v29, v29
    v_exp_f32 v30, v30
    v_exp_f32 v31, v31
    s_nop 0
    v_cvt_pk_bf16_f32 v20, v28, v29
    v_cvt_pk_bf16_f32 v21, v30, v31
    s_waitcnt vmcnt(7)
    s_cmp_gt_u32 s17, 156
    s_cbranch_scc1 L_x156
    s_waitcnt vmcnt(5)
    s_cmp_gt_u32 s16, 156
    s_cbranch_scc1 L_x156
    s_waitcnt vmcnt(4)
L_x156:
    s_add_u32 m0, s63, 12288
    s_add_u32 s67, s64, 12599296
    buffer_load_dwordx4 v2, s[32:35], s67 offen offset:0 nt lds
    s_waitcnt vmcnt(7)
    s_cmp_gt_u32 s17, 157
    s_cbranch_scc1 L_x157
    s_waitcnt vmcnt(5)
    s_cmp_gt_u32 s16, 157
    s_cbranch_scc1 L_x157
    s_waitcnt vmcnt(4)
L_x157:
    buffer_load_dwordx4 v3, s[32:35], s67 offen offset:1024 nt lds
    s_waitcnt vmcnt(7)
    s_cmp_gt_u32 s17, 158
    s_cbranch_scc1 L_x158
    s_waitcnt vmcnt(5)
    s_cmp_gt_u32 s16, 158
    s_cbranch_scc1 L_x158
    s_waitcnt vmcnt(4)
L_x158:
    s_add_u32 s67, s64, 12605440
    buffer_load_dwordx4 v4, s[32:35], s67 offen offset:2048 nt lds
    s_waitcnt vmcnt(7)
    s_cmp_gt_u32 s17, 159
    s_cbranch_scc1 L_x159
    s_waitcnt vmcnt(5)
    s_cmp_gt_u32 s16, 159
    s_cbranch_scc1 L_x159
    s_waitcnt vmcnt(4)
L_x159:
    buffer_load_dwordx4 v5, s[32:35], s67 offen offset:3072 nt lds
    ds_read_b64 v[242:243], v254
    ds_read_b64_tr_b16 v[32:33], v10 offset:0
    ds_read_b64_tr_b16 v[34:35], v10 offset:128
    ds_read_b64_tr_b16 v[36:37], v10 offset:256
    ds_read_b64_tr_b16 v[38:39], v10 offset:384
    ds_read_b64_tr_b16 v[40:41], v10 offset:2176
    ds_read_b64_tr_b16 v[42:43], v10 offset:2048
    ds_read_b64_tr_b16 v[44:45], v10 offset:2432
    ds_read_b64_tr_b16 v[46:47], v10 offset:2304
    ds_read_b64_tr_b16 v[48:49], v10 offset:4096
    ds_read_b64_tr_b16 v[50:51], v10 offset:4224
    ds_read_b64_tr_b16 v[52:53], v10 offset:4352
    ds_read_b64_tr_b16 v[54:55], v10 offset:4480
    ds_read_b64_tr_b16 v[56:57], v10 offset:6272
    ds_read_b64_tr_b16 v[58:59], v10 offset:6144
    ds_read_b64_tr_b16 v[60:61], v10 offset:6528
    ds_read_b64_tr_b16 v[62:63], v10 offset:6400
    s_waitcnt vmcnt(7)
    s_cmp_gt_u32 s17, 160
    s_cbranch_scc1 L_x160
    s_waitcnt vmcnt(5)
    s_cmp_gt_u32 s16, 160
    s_cbranch_scc1 L_x160
    s_waitcnt vmcnt(4)
L_x160:
    s_add_u32 m0, s63, 16384
    s_add_u32 s67, s64, 131072
    buffer_load_dwordx4 v2, s[32:35], s67 offen offset:0 nt lds
    s_waitcnt lgkmcnt(0)
    v_readfirstlane_b32 s16, v242
    v_readfirstlane_b32 s17, v243
    v_mfma_f32_4x4x4_16b_bf16 v[96:99], v[20:21], v[32:33], v[96:99] cbsz:4 abid:0
    v_mfma_f32_4x4x4_16b_bf16 v[100:103], v[20:21], v[34:35], v[100:103] cbsz:4 abid:0
    v_mfma_f32_4x4x4_16b_bf16 v[104:107], v[20:21], v[36:37], v[104:107] cbsz:4 abid:0
    v_mfma_f32_4x4x4_16b_bf16 v[108:111], v[20:21], v[38:39], v[108:111] cbsz:4 abid:0
    v_mfma_f32_4x4x4_16b_bf16 v[96:99], v[20:21], v[40:41], v[96:99] cbsz:4 abid:4
    v_mfma_f32_4x4x4_16b_bf16 v[100:103], v[20:21], v[42:43], v[100:103] cbsz:4 abid:4
    v_mfma_f32_4x4x4_16b_bf16 v[104:107], v[20:21], v[44:45], v[104:107] cbsz:4 abid:4
    v_mfma_f32_4x4x4_16b_bf16 v[108:111], v[20:21], v[46:47], v[108:111] cbsz:4 abid:4
    v_mfma_f32_4x4x4_16b_bf16 v[96:99], v[20:21], v[48:49], v[96:99] cbsz:4 abid:8
    v_mfma_f32_4x4x4_16b_bf16 v[100:103], v[20:21], v[50:51], v[100:103] cbsz:4 abid:8
    v_mfma_f32_4x4x4_16b_bf16 v[104:107], v[20:21], v[52:53], v[104:107] cbsz:4 abid:8
    v_mfma_f32_4x4x4_16b_bf16 v[108:111], v[20:21], v[54:55], v[108:111] cbsz:4 abid:8
    v_mfma_f32_4x4x4_16b_bf16 v[96:99], v[20:21], v[56:57], v[96:99] cbsz:4 abid:12
    v_mfma_f32_4x4x4_16b_bf16 v[100:103], v[20:21], v[58:59], v[100:103] cbsz:4 abid:12
    v_mfma_f32_4x4x4_16b_bf16 v[104:107], v[20:21], v[60:61], v[104:107] cbsz:4 abid:12
    v_mfma_f32_4x4x4_16b_bf16 v[108:111], v[20:21], v[62:63], v[108:111] cbsz:4 abid:12
    s_waitcnt vmcnt(7)
    s_cmp_gt_u32 s17, 161
    s_cbranch_scc1 L_x161
    s_waitcnt vmcnt(5)
    s_cmp_gt_u32 s16, 161
    s_cbranch_scc1 L_x161
    s_waitcnt vmcnt(4)
L_x161:
    buffer_load_dwordx4 v3, s[32:35], s67 offen offset:1024 nt lds
    v_fma_f32 v28, v200, s65, -v19
    v_fma_f32 v29, v201, s65, -v19
    v_fma_f32 v30, v202, s65, -v19
    v_fma_f32 v31, v203, s65, -v19
    v_exp_f32 v28, v28
    v_exp_f32 v29, v29
    v_exp_f32 v30, v30
    v_exp_f32 v31, v31
    s_nop 0
    v_add_f32 v24, v24, v28
    v_add_f32 v25, v25, v29
    v_add_f32 v24, v24, v30
    v_add_f32 v25, v25, v31
    v_fma_f32 v28, v204, s65, -v19
    v_fma_f32 v29, v205, s65, -v19
    v_fma_f32 v30, v206, s65, -v19
    v_fma_f32 v31, v207, s65, -v19
    v_exp_f32 v28, v28
    v_exp_f32 v29, v29
    v_exp_f32 v30, v30
    v_exp_f32 v31, v31
    s_nop 0
    v_add_f32 v24, v24, v28
    v_add_f32 v25, v25, v29
    v_add_f32 v24, v24, v30
    v_add_f32 v25, v25, v31
    s_waitcnt vmcnt(7)
    s_cmp_gt_u32 s17, 162
    s_cbranch_scc1 L_x162
    s_waitcnt vmcnt(5)
    s_cmp_gt_u32 s16, 162
    s_cbranch_scc1 L_x162
    s_waitcnt vmcnt(4)
L_x162:
    s_add_u32 s67, s64, 137216
    buffer_load_dwordx4 v4, s[32:35], s67 offen offset:2048 nt lds
    v_fma_f32 v28, v208, s65, -v19
    v_fma_f32 v29, v209, s65, -v19
    v_fma_f32 v30, v210, s65, -v19
    v_fma_f32 v31, v211, s65, -v19
    v_exp_f32 v28, v28
    v_exp_f32 v29, v29
    v_exp_f32 v30, v30
    v_exp_f32 v31, v31
    s_nop 0
    v_add_f32 v24, v24, v28
    v_add_f32 v25, v25, v29
    v_add_f32 v24, v24, v30
    v_add_f32 v25, v25, v31
    v_fma_f32 v28, v212, s65, -v19
    v_fma_f32 v29, v213, s65, -v19
    v_fma_f32 v30, v214, s65, -v19
    v_fma_f32 v31, v215, s65, -v19
    v_exp_f32 v28, v28
    v_exp_f32 v29, v29
    v_exp_f32 v30, v30
    v_exp_f32 v31, v31
    s_nop 0
    v_add_f32 v24, v24, v28
    v_add_f32 v25, v25, v29
    v_add_f32 v24, v24, v30
    v_add_f32 v25, v25, v31
    s_waitcnt vmcnt(7)
    s_cmp_gt_u32 s17, 163
    s_cbranch_scc1 L_x163
    s_waitcnt vmcnt(5)
    s_cmp_gt_u32 s16, 163
    s_cbranch_scc1 L_x163
    s_waitcnt vmcnt(4)
L_x163:
    buffer_load_dwordx4 v5, s[32:35], s67 offen offset:3072 nt lds
    v_fma_f32 v28, v216, s65, -v19
    v_fma_f32 v29, v217, s65, -v19
    v_fma_f32 v30, v218, s65, -v19
    v_fma_f32 v31, v219, s65, -v19
    v_exp_f32 v28, v28
    v_exp_f32 v29, v29
    v_exp_f32 v30, v30
    v_exp_f32 v31, v31
    s_nop 0
    v_add_f32 v24, v24, v28
    v_add_f32 v25, v25, v29
    v_add_f32 v24, v24, v30
    v_add_f32 v25, v25, v31
    v_fma_f32 v28, v220, s65, -v19
    v_fma_f32 v29, v221, s65, -v19
    v_fma_f32 v30, v222, s65, -v19
    v_fma_f32 v31, v223, s65, -v19
    v_exp_f32 v28, v28
    v_exp_f32 v29, v29
    v_exp_f32 v30, v30
    v_exp_f32 v31, v31
    s_nop 0
    v_add_f32 v24, v24, v28
    v_add_f32 v25, v25, v29
    v_add_f32 v24, v24, v30
    v_add_f32 v25, v25, v31
    s_waitcnt vmcnt(7)
    s_cmp_gt_u32 s17, 164
    s_cbranch_scc1 L_x164
    s_waitcnt vmcnt(5)
    s_cmp_gt_u32 s16, 164
    s_cbranch_scc1 L_x164
    s_waitcnt vmcnt(4)
L_x164:
    s_add_u32 m0, s63, 20480
    s_add_u32 s67, s64, 147456
    buffer_load_dwordx4 v2, s[32:35], s67 offen offset:0 nt lds
    v_add_f32 v226, v24, v25
    v_mov_b32 v228, v226
    s_nop 1
    v_permlane16_swap_b32 v226, v228
    s_nop 0
    v_add_f32 v226, v226, v228
    v_mov_b32 v228, v226
    s_nop 1
    v_permlane32_swap_b32 v226, v228
    s_nop 0
    v_add_f32 v226, v226, v228
    v_mov_b32 v224, v19
    v_mov_b32 v225, 0x600df1a6
    v_mov_b32 v227, 0x600df1a6
    s_lshl_b32 s72, s3, 5
    s_add_u32 s72, s72, 159744
    v_lshlrev_b32 v228, 4, v1
    v_add_u32 v228, s72, v228
    s_mov_b64 exec, 3
    ds_write_b128 v228, v[224:227]
    s_mov_b64 exec, -1
    s_waitcnt vmcnt(7)
    s_cmp_gt_u32 s17, 165
    s_cbranch_scc1 L_x165
    s_waitcnt vmcnt(5)
    s_cmp_gt_u32 s16, 165
    s_cbranch_scc1 L_x165
    s_waitcnt vmcnt(4)
L_x165:
    buffer_load_dwordx4 v3, s[32:35], s67 offen offset:1024 nt lds
    v_fma_f32 v28, v172, s65, -v19
    v_fma_f32 v29, v173, s65, -v19
    v_fma_f32 v30, v174, s65, -v19
    v_fma_f32 v31, v175, s65, -v19
    v_exp_f32 v28, v28
    v_exp_f32 v29, v29
    v_exp_f32 v30, v30
    v_exp_f32 v31, v31
    s_nop 0
    v_cvt_pk_bf16_f32 v22, v28, v29
    v_cvt_pk_bf16_f32 v23, v30, v31
    s_waitcnt vmcnt(7)
    s_cmp_gt_u32 s17, 166
    s_cbranch_scc1 L_x166
    s_waitcnt vmcnt(5)
    s_cmp_gt_u32 s16, 166
    s_cbranch_scc1 L_x166
    s_waitcnt vmcnt(4)
L_x166:
    s_add_u32 s67, s64, 153600
    buffer_load_dwordx4 v4, s[32:35], s67 offen offset:2048 nt lds
    s_waitcnt vmcnt(7)
    s_cmp_gt_u32 s17, 167
    s_cbranch_scc1 L_x167
    s_waitcnt vmcnt(5)
    s_cmp_gt_u32 s16, 167
    s_cbranch_scc1 L_x167
    s_waitcnt vmcnt(4)
L_x167:
    buffer_load_dwordx4 v5, s[32:35], s67 offen offset:3072 nt lds
    ds_read_b64 v[242:243], v254
    ds_read_b64_tr_b16 v[32:33], v10 offset:8192
    ds_read_b64_tr_b16 v[34:35], v10 offset:8320
    ds_read_b64_tr_b16 v[36:37], v10 offset:8448
    ds_read_b64_tr_b16 v[38:39], v10 offset:8576
    ds_read_b64_tr_b16 v[40:41], v10 offset:10368
    ds_read_b64_tr_b16 v[42:43], v10 offset:10240
    ds_read_b64_tr_b16 v[44:45], v10 offset:10624
    ds_read_b64_tr_b16 v[46:47], v10 offset:10496
    ds_read_b64_tr_b16 v[48:49], v10 offset:12288
    ds_read_b64_tr_b16 v[50:51], v10 offset:12416
    ds_read_b64_tr_b16 v[52:53], v10 offset:12544
    ds_read_b64_tr_b16 v[54:55], v10 offset:12672
    ds_read_b64_tr_b16 v[56:57], v10 offset:14464
    ds_read_b64_tr_b16 v[58:59], v10 offset:14336
    ds_read_b64_tr_b16 v[60:61], v10 offset:14720
    ds_read_b64_tr_b16 v[62:63], v10 offset:14592
    s_waitcnt vmcnt(7)
    s_cmp_gt_u32 s17, 168
    s_cbranch_scc1 L_x168
    s_waitcnt vmcnt(5)
    s_cmp_gt_u32 s16, 168
    s_cbranch_scc1 L_x168
    s_waitcnt vmcnt(4)
L_x168:
    s_add_u32 m0, s63, 0
    s_add_u32 s67, s64, 4325376
    buffer_load_dwordx4 v2, s[32:35], s67 offen offset:0 nt lds
    s_waitcnt lgkmcnt(0)
    v_readfirstlane_b32 s16, v242
    v_readfirstlane_b32 s17, v243
    v_mfma_f32_4x4x4_16b_bf16 v[96:99], v[22:23], v[32:33], v[96:99] cbsz:4 abid:0
    v_mfma_f32_4x4x4_16b_bf16 v[100:103], v[22:23], v[34:35], v[100:103] cbsz:4 abid:0
    v_mfma_f32_4x4x4_16b_bf16 v[104:107], v[22:23], v[36:37], v[104:107] cbsz:4 abid:0
    v_mfma_f32_4x4x4_16b_bf16 v[108:111], v[22:23], v[38:39], v[108:111] cbsz:4 abid:0
    v_mfma_f32_4x4x4_16b_bf16 v[96:99], v[22:23], v[40:41], v[96:99] cbsz:4 abid:4
    v_mfma_f32_4x4x4_16b_bf16 v[100:103], v[22:23], v[42:43], v[100:103] cbsz:4 abid:4
    v_mfma_f32_4x4x4_16b_bf16 v[104:107], v[22:23], v[44:45], v[104:107] cbsz:4 abid:4
    v_mfma_f32_4x4x4_16b_bf16 v[108:111], v[22:23], v[46:47], v[108:111] cbsz:4 abid:4
    v_mfma_f32_4x4x4_16b_bf16 v[96:99], v[22:23], v[48:49], v[96:99] cbsz:4 abid:8
    v_mfma_f32_4x4x4_16b_bf16 v[100:103], v[22:23], v[50:51], v[100:103] cbsz:4 abid:8
    v_mfma_f32_4x4x4_16b_bf16 v[104:107], v[22:23], v[52:53], v[104:107] cbsz:4 abid:8
    v_mfma_f32_4x4x4_16b_bf16 v[108:111], v[22:23], v[54:55], v[108:111] cbsz:4 abid:8
    v_mfma_f32_4x4x4_16b_bf16 v[96:99], v[22:23], v[56:57], v[96:99] cbsz:4 abid:12
    v_mfma_f32_4x4x4_16b_bf16 v[100:103], v[22:23], v[58:59], v[100:103] cbsz:4 abid:12
    v_mfma_f32_4x4x4_16b_bf16 v[104:107], v[22:23], v[60:61], v[104:107] cbsz:4 abid:12
    v_mfma_f32_4x4x4_16b_bf16 v[108:111], v[22:23], v[62:63], v[108:111] cbsz:4 abid:12
    s_waitcnt vmcnt(7)
    s_cmp_gt_u32 s17, 169
    s_cbranch_scc1 L_x169
    s_waitcnt vmcnt(5)
    s_cmp_gt_u32 s16, 169
    s_cbranch_scc1 L_x169
    s_waitcnt vmcnt(4)
L_x169:
    buffer_load_dwordx4 v3, s[32:35], s67 offen offset:1024 nt lds
    v_fma_f32 v28, v176, s65, -v19
    v_fma_f32 v29, v177, s65, -v19
    v_fma_f32 v30, v178, s65, -v19
    v_fma_f32 v31, v179, s65, -v19
    v_exp_f32 v28, v28
    v_exp_f32 v29, v29
    v_exp_f32 v30, v30
    v_exp_f32 v31, v31
    s_nop 0
    v_cvt_pk_bf16_f32 v20, v28, v29
    v_cvt_pk_bf16_f32 v21, v30, v31
    s_waitcnt vmcnt(7)
    s_cmp_gt_u32 s17, 170
    s_cbranch_scc1 L_x170
    s_waitcnt vmcnt(5)
    s_cmp_gt_u32 s16, 170
    s_cbranch_scc1 L_x170
    s_waitcnt vmcnt(4)
L_x170:
    s_add_u32 s67, s64, 4331520
    buffer_load_dwordx4 v4, s[32:35], s67 offen offset:2048 nt lds
    s_waitcnt vmcnt(7)
    s_cmp_gt_u32 s17, 171
    s_cbranch_scc1 L_x171
    s_waitcnt vmcnt(5)
    s_cmp_gt_u32 s16, 171
    s_cbranch_scc1 L_x171
    s_waitcnt vmcnt(4)
L_x171:
    buffer_load_dwordx4 v5, s[32:35], s67 offen offset:3072 nt lds
    s_waitcnt vmcnt(7)
    s_cmp_gt_u32 s17, 172
    s_cbranch_scc1 L_x172
    s_waitcnt vmcnt(5)
    s_cmp_gt_u32 s16, 172
    s_cbranch_scc1 L_x172
    s_waitcnt vmcnt(4)
L_x172:
    s_add_u32 m0, s63, 4096
    s_add_u32 s67, s64, 4341760
    buffer_load_dwordx4 v2, s[32:35], s67 offen offset:0 nt lds
    s_waitcnt vmcnt(7)
    s_cmp_gt_u32 s17, 173
    s_cbranch_scc1 L_x173
    s_waitcnt vmcnt(5)
    s_cmp_gt_u32 s16, 173
    s_cbranch_scc1 L_x173
    s_waitcnt vmcnt(4)
L_x173:
    buffer_load_dwordx4 v3, s[32:35], s67 offen offset:1024 nt lds
    s_waitcnt vmcnt(7)
    s_cmp_gt_u32 s17, 174
    s_cbranch_scc1 L_x174
    s_waitcnt vmcnt(5)
    s_cmp_gt_u32 s16, 174
    s_cbranch_scc1 L_x174
    s_waitcnt vmcnt(4)
L_x174:
    s_add_u32 s67, s64, 4347904
    buffer_load_dwordx4 v4, s[32:35], s67 offen offset:2048 nt lds
    s_waitcnt vmcnt(7)
    s_cmp_gt_u32 s17, 175
    s_cbranch_scc1 L_x175
    s_waitcnt vmcnt(5)
    s_cmp_gt_u32 s16, 175
    s_cbranch_scc1 L_x175
    s_waitcnt vmcnt(4)
L_x175:
    buffer_load_dwordx4 v5, s[32:35], s67 offen offset:3072 nt lds
    v_mov_b32 v255, 1
    s_mov_b64 exec, 1
    ds_add_rtn_u32 v255, v254, v255 offset:20
    s_mov_b64 exec, -1
    ds_read_b64 v[242:243], v254
    ds_read_b64_tr_b16 v[32:33], v10 offset:16384
    ds_read_b64_tr_b16 v[34:35], v10 offset:16512
    ds_read_b64_tr_b16 v[36:37], v10 offset:16640
    ds_read_b64_tr_b16 v[38:39], v10 offset:16768
    ds_read_b64_tr_b16 v[40:41], v10 offset:18560
    ds_read_b64_tr_b16 v[42:43], v10 offset:18432
    ds_read_b64_tr_b16 v[44:45], v10 offset:18816
    ds_read_b64_tr_b16 v[46:47], v10 offset:18688
    ds_read_b64_tr_b16 v[48:49], v10 offset:20480
    ds_read_b64_tr_b16 v[50:51], v10 offset:20608
    ds_read_b64_tr_b16 v[52:53], v10 offset:20736
    ds_read_b64_tr_b16 v[54:55], v10 offset:20864
    ds_read_b64_tr_b16 v[56:57], v10 offset:22656
    ds_read_b64_tr_b16 v[58:59], v10 offset:22528
    ds_read_b64_tr_b16 v[60:61], v10 offset:22912
    ds_read_b64_tr_b16 v[62:63], v10 offset:22784
    s_waitcnt vmcnt(7)
    s_cmp_gt_u32 s17, 176
    s_cbranch_scc1 L_x176
    s_waitcnt vmcnt(5)
    s_cmp_gt_u32 s16, 176
    s_cbranch_scc1 L_x176
    s_waitcnt vmcnt(4)
L_x176:
    s_add_u32 m0, s63, 8192
    s_add_u32 s67, s64, 8519680
    buffer_load_dwordx4 v2, s[32:35], s67 offen offset:0 nt lds
    s_waitcnt lgkmcnt(0)
    v_readfirstlane_b32 s16, v242
    v_readfirstlane_b32 s17, v243
    v_readfirstlane_b32 s14, v255
    s_sub_u32 s14, s14, s15
    s_cmp_eq_u32 s14, 0
    s_cbranch_scc0 L_ra3_20
    s_mov_b32 s18, 1
    s_atomic_add s18, s[22:23], 104448 glc
L_ra3_20:
    v_mfma_f32_4x4x4_16b_bf16 v[96:99], v[20:21], v[32:33], v[96:99] cbsz:4 abid:0
    v_mfma_f32_4x4x4_16b_bf16 v[100:103], v[20:21], v[34:35], v[100:103] cbsz:4 abid:0
    v_mfma_f32_4x4x4_16b_bf16 v[104:107], v[20:21], v[36:37], v[104:107] cbsz:4 abid:0
    v_mfma_f32_4x4x4_16b_bf16 v[108:111], v[20:21], v[38:39], v[108:111] cbsz:4 abid:0
    v_mfma_f32_4x4x4_16b_bf16 v[96:99], v[20:21], v[40:41], v[96:99] cbsz:4 abid:4
    v_mfma_f32_4x4x4_16b_bf16 v[100:103], v[20:21], v[42:43], v[100:103] cbsz:4 abid:4
    v_mfma_f32_4x4x4_16b_bf16 v[104:107], v[20:21], v[44:45], v[104:107] cbsz:4 abid:4
    v_mfma_f32_4x4x4_16b_bf16 v[108:111], v[20:21], v[46:47], v[108:111] cbsz:4 abid:4
    v_mfma_f32_4x4x4_16b_bf16 v[96:99], v[20:21], v[48:49], v[96:99] cbsz:4 abid:8
    v_mfma_f32_4x4x4_16b_bf16 v[100:103], v[20:21], v[50:51], v[100:103] cbsz:4 abid:8
    v_mfma_f32_4x4x4_16b_bf16 v[104:107], v[20:21], v[52:53], v[104:107] cbsz:4 abid:8
    v_mfma_f32_4x4x4_16b_bf16 v[108:111], v[20:21], v[54:55], v[108:111] cbsz:4 abid:8
    v_mfma_f32_4x4x4_16b_bf16 v[96:99], v[20:21], v[56:57], v[96:99] cbsz:4 abid:12
    v_mfma_f32_4x4x4_16b_bf16 v[100:103], v[20:21], v[58:59], v[100:103] cbsz:4 abid:12
    v_mfma_f32_4x4x4_16b_bf16 v[104:107], v[20:21], v[60:61], v[104:107] cbsz:4 abid:12
    v_mfma_f32_4x4x4_16b_bf16 v[108:111], v[20:21], v[62:63], v[108:111] cbsz:4 abid:12
    s_waitcnt vmcnt(7)
    s_cmp_gt_u32 s17, 177
    s_cbranch_scc1 L_x177
    s_waitcnt vmcnt(5)
    s_cmp_gt_u32 s16, 177
    s_cbranch_scc1 L_x177
    s_waitcnt vmcnt(4)
L_x177:
    buffer_load_dwordx4 v3, s[32:35], s67 offen offset:1024 nt lds
    v_fma_f32 v28, v180, s65, -v19
    v_fma_f32 v29, v181, s65, -v19
    v_fma_f32 v30, v182, s65, -v19
    v_fma_f32 v31, v183, s65, -v19
    v_exp_f32 v28, v28
    v_exp_f32 v29, v29
    v_exp_f32 v30, v30
    v_exp_f32 v31, v31
    s_nop 0
    v_cvt_pk_bf16_f32 v22, v28, v29
    v_cvt_pk_bf16_f32 v23, v30, v31
    s_waitcnt vmcnt(7)
    s_cmp_gt_u32 s17, 178
    s_cbranch_scc1 L_x178
    s_waitcnt vmcnt(5)
    s_cmp_gt_u32 s16, 178
    s_cbranch_scc1 L_x178
    s_waitcnt vmcnt(4)
L_x178:
    s_add_u32 s67, s64, 8525824
    buffer_load_dwordx4 v4, s[32:35], s67 offen offset:2048 nt lds
    s_waitcnt vmcnt(7)
    s_cmp_gt_u32 s17, 179
    s_cbranch_scc1 L_x179
    s_waitcnt vmcnt(5)
    s_cmp_gt_u32 s16, 179
    s_cbranch_scc1 L_x179
    s_waitcnt vmcnt(4)
L_x179:
    buffer_load_dwordx4 v5, s[32:35], s67 offen offset:3072 nt lds
    s_waitcnt vmcnt(7)
    s_cmp_gt_u32 s17, 180
    s_cbranch_scc1 L_x180
    s_waitcnt vmcnt(5)
    s_cmp_gt_u32 s16, 180
    s_cbranch_scc1 L_x180
    s_waitcnt vmcnt(4)
L_x180:
    s_add_u32 m0, s63, 12288
    s_add_u32 s67, s64, 8536064
    buffer_load_dwordx4 v2, s[32:35], s67 offen offset:0 nt lds
    s_waitcnt vmcnt(7)
    s_cmp_gt_u32 s17, 181
    s_cbranch_scc1 L_x181
    s_waitcnt vmcnt(5)
    s_cmp_gt_u32 s16, 181
    s_cbranch_scc1 L_x181
    s_waitcnt vmcnt(4)
L_x181:
    buffer_load_dwordx4 v3, s[32:35], s67 offen offset:1024 nt lds
    s_waitcnt vmcnt(7)
    s_cmp_gt_u32 s17, 182
    s_cbranch_scc1 L_x182
    s_waitcnt vmcnt(5)
    s_cmp_gt_u32 s16, 182
    s_cbranch_scc1 L_x182
    s_waitcnt vmcnt(4)
L_x182:
    s_add_u32 s67, s64, 8542208
    buffer_load_dwordx4 v4, s[32:35], s67 offen offset:2048 nt lds
    s_waitcnt vmcnt(7)
    s_cmp_gt_u32 s17, 183
    s_cbranch_scc1 L_x183
    s_waitcnt vmcnt(5)
    s_cmp_gt_u32 s16, 183
    s_cbranch_scc1 L_x183
    s_waitcnt vmcnt(4)
L_x183:
    buffer_load_dwordx4 v5, s[32:35], s67 offen offset:3072 nt lds
    ds_read_b64 v[242:243], v254
    ds_read_b64_tr_b16 v[32:33], v10 offset:0
    ds_read_b64_tr_b16 v[34:35], v10 offset:128
    ds_read_b64_tr_b16 v[36:37], v10 offset:256
    ds_read_b64_tr_b16 v[38:39], v10 offset:384
    ds_read_b64_tr_b16 v[40:41], v10 offset:2176
    ds_read_b64_tr_b16 v[42:43], v10 offset:2048
    ds_read_b64_tr_b16 v[44:45], v10 offset:2432
    ds_read_b64_tr_b16 v[46:47], v10 offset:2304
    ds_read_b64_tr_b16 v[48:49], v10 offset:4096
    ds_read_b64_tr_b16 v[50:51], v10 offset:4224
    ds_read_b64_tr_b16 v[52:53], v10 offset:4352
    ds_read_b64_tr_b16 v[54:55], v10 offset:4480
    ds_read_b64_tr_b16 v[56:57], v10 offset:6272
    ds_read_b64_tr_b16 v[58:59], v10 offset:6144
    ds_read_b64_tr_b16 v[60:61], v10 offset:6528
    ds_read_b64_tr_b16 v[62:63], v10 offset:6400
    s_waitcnt vmcnt(7)
    s_cmp_gt_u32 s17, 184
    s_cbranch_scc1 L_x184
    s_waitcnt vmcnt(5)
    s_cmp_gt_u32 s16, 184
    s_cbranch_scc1 L_x184
    s_waitcnt vmcnt(4)
L_x184:
    s_add_u32 m0, s63, 16384
    s_add_u32 s67, s64, 12713984
    buffer_load_dwordx4 v2, s[32:35], s67 offen offset:0 nt lds
    s_waitcnt lgkmcnt(0)
    v_readfirstlane_b32 s16, v242
    v_readfirstlane_b32 s17, v243
    s_cmp_eq_u32 s14, 0
    s_cbranch_scc0 L_rkd3_0
    s_sub_u32 s16, s18, 18
    s_mul_i32 s16, s16, 8
    s_add_u32 s16, s16, 189
    s_cmp_gt_u32 s18, 18
    s_cselect_b32 s16, s16, 0
    s_sub_u32 s17, s18, 26
    s_mul_i32 s17, s17, 8
    s_add_u32 s17, s17, 189
    s_cmp_gt_u32 s18, 26
    s_cselect_b32 s17, s17, 0
    v_mov_b32 v242, s16
    v_mov_b32 v243, s17
    ds_write_b64 v254, v[242:243]
L_rkd3_0:
    v_mfma_f32_4x4x4_16b_bf16 v[96:99], v[22:23], v[32:33], v[96:99] cbsz:4 abid:0
    v_mfma_f32_4x4x4_16b_bf16 v[100:103], v[22:23], v[34:35], v[100:103] cbsz:4 abid:0
    v_mfma_f32_4x4x4_16b_bf16 v[104:107], v[22:23], v[36:37], v[104:107] cbsz:4 abid:0
    v_mfma_f32_4x4x4_16b_bf16 v[108:111], v[22:23], v[38:39], v[108:111] cbsz:4 abid:0
    v_mfma_f32_4x4x4_16b_bf16 v[96:99], v[22:23], v[40:41], v[96:99] cbsz:4 abid:4
    v_mfma_f32_4x4x4_16b_bf16 v[100:103], v[22:23], v[42:43], v[100:103] cbsz:4 abid:4
    v_mfma_f32_4x4x4_16b_bf16 v[104:107], v[22:23], v[44:45], v[104:107] cbsz:4 abid:4
    v_mfma_f32_4x4x4_16b_bf16 v[108:111], v[22:23], v[46:47], v[108:111] cbsz:4 abid:4
    v_mfma_f32_4x4x4_16b_bf16 v[96:99], v[22:23], v[48:49], v[96:99] cbsz:4 abid:8
    v_mfma_f32_4x4x4_16b_bf16 v[100:103], v[22:23], v[50:51], v[100:103] cbsz:4 abid:8
    v_mfma_f32_4x4x4_16b_bf16 v[104:107], v[22:23], v[52:53], v[104:107] cbsz:4 abid:8
    v_mfma_f32_4x4x4_16b_bf16 v[108:111], v[22:23], v[54:55], v[108:111] cbsz:4 abid:8
    v_mfma_f32_4x4x4_16b_bf16 v[96:99], v[22:23], v[56:57], v[96:99] cbsz:4 abid:12
    v_mfma_f32_4x4x4_16b_bf16 v[100:103], v[22:23], v[58:59], v[100:103] cbsz:4 abid:12
    v_mfma_f32_4x4x4_16b_bf16 v[104:107], v[22:23], v[60:61], v[104:107] cbsz:4 abid:12
    v_mfma_f32_4x4x4_16b_bf16 v[108:111], v[22:23], v[62:63], v[108:111] cbsz:4 abid:12
    s_waitcnt vmcnt(7)
    s_cmp_gt_u32 s17, 185
    s_cbranch_scc1 L_x185
    s_waitcnt vmcnt(5)
    s_cmp_gt_u32 s16, 185
    s_cbranch_scc1 L_x185
    s_waitcnt vmcnt(4)
L_x185:
    buffer_load_dwordx4 v3, s[32:35], s67 offen offset:1024 nt lds
    s_cmp_eq_u32 s3, 0
    s_cbranch_scc0 L_nopub
    v_and_b32 v228, 7, v1
    v_lshlrev_b32 v228, 4, v228
    v_add_u32 v228, 159744, v228
    s_mov_b32 s72, 16000000
L_lml:
    ds_read_b128 v[224:227], v228
    s_waitcnt lgkmcnt(0)
    v_and_b32 v229, v225, v227
    v_cmp_ne_u32 vcc, 0x600df1a6, v229
    s_cbranch_vccz L_lmlok
    s_sub_u32 s72, s72, 1
    s_cbranch_scc0 L_lml
L_lmlok:
    v_mov_b32 v229, v224
    s_nop 1
    v_max_f32_dpp v229, v229, v229 row_ror:2 row_mask:0xf bank_mask:0xf
    s_nop 1
    v_max_f32_dpp v229, v229, v229 row_ror:4 row_mask:0xf bank_mask:0xf
    v_sub_f32 v224, v224, v229
    v_exp_f32 v224, v224
    s_nop 0
    v_mul_f32 v226, v226, v224
    s_nop 1
    v_add_f32_dpp v226, v226, v226 row_ror:2 row_mask:0xf bank_mask:0xf
    s_nop 1
    v_add_f32_dpp v226, v226, v226 row_ror:4 row_mask:0xf bank_mask:0xf
    v_mov_b32 v224, v229
    v_mov_b32 v225, s62
    v_xor_b32 v227, s83, v225
    s_lshl_b32 s72, s60, 10
    s_lshl_b32 s73, s61, 5
    s_add_u32 s72, s72, s73
    s_add_u32 s72, s72, 32768
    v_lshlrev_b32 v228, 4, v1
    s_mov_b64 exec, 3
    buffer_store_dwordx4 v[224:227], v228, s[48:51], s72 offen sc1
    s_mov_b64 exec, -1
L_nopub:
    s_waitcnt vmcnt(7)
    s_cmp_gt_u32 s17, 186
    s_cbranch_scc1 L_x186
    s_waitcnt vmcnt(5)
    s_cmp_gt_u32 s16, 186
    s_cbranch_scc1 L_x186
    s_waitcnt vmcnt(4)
L_x186:
    s_add_u32 s67, s64, 12720128
    buffer_load_dwordx4 v4, s[32:35], s67 offen offset:2048 nt lds
    v_fma_f32 v28, v184, s65, -v19
    v_fma_f32 v29, v185, s65, -v19
    v_fma_f32 v30, v186, s65, -v19
    v_fma_f32 v31, v187, s65, -v19
    v_exp_f32 v28, v28
    v_exp_f32 v29, v29
    v_exp_f32 v30, v30
    v_exp_f32 v31, v31
    s_nop 0
    v_cvt_pk_bf16_f32 v20, v28, v29
    v_cvt_pk_bf16_f32 v21, v30, v31
    s_waitcnt vmcnt(7)
    s_cmp_gt_u32 s17, 187
    s_cbranch_scc1 L_x187
    s_waitcnt vmcnt(5)
    s_cmp_gt_u32 s16, 187
    s_cbranch_scc1 L_x187
    s_waitcnt vmcnt(4)
L_x187:
    buffer_load_dwordx4 v5, s[32:35], s67 offen offset:3072 nt lds
    s_waitcnt vmcnt(7)
    s_cmp_gt_u32 s17, 188
    s_cbranch_scc1 L_x188
    s_waitcnt vmcnt(5)
    s_cmp_gt_u32 s16, 188
    s_cbranch_scc1 L_x188
    s_waitcnt vmcnt(4)
L_x188:
    s_add_u32 m0, s63, 20480
    s_add_u32 s67, s64, 12730368
    buffer_load_dwordx4 v2, s[32:35], s67 offen offset:0 nt lds
    s_waitcnt vmcnt(7)
    s_cmp_gt_u32 s17, 189
    s_cbranch_scc1 L_x189
    s_waitcnt vmcnt(5)
    s_cmp_gt_u32 s16, 189
    s_cbranch_scc1 L_x189
    s_waitcnt vmcnt(4)
L_x189:
    buffer_load_dwordx4 v3, s[32:35], s67 offen offset:1024 nt lds
    s_waitcnt vmcnt(7)
    s_cmp_gt_u32 s17, 190
    s_cbranch_scc1 L_x190
    s_waitcnt vmcnt(5)
    s_cmp_gt_u32 s16, 190
    s_cbranch_scc1 L_x190
    s_waitcnt vmcnt(4)
L_x190:
    s_add_u32 s67, s64, 12736512
    buffer_load_dwordx4 v4, s[32:35], s67 offen offset:2048 nt lds
    s_waitcnt vmcnt(7)
    s_cmp_gt_u32 s17, 191
    s_cbranch_scc1 L_x191
    s_waitcnt vmcnt(5)
    s_cmp_gt_u32 s16, 191
    s_cbranch_scc1 L_x191
    s_waitcnt vmcnt(4)
L_x191:
    buffer_load_dwordx4 v5, s[32:35], s67 offen offset:3072 nt lds
    ds_read_b64 v[242:243], v254
    ds_read_b64_tr_b16 v[32:33], v10 offset:8192
    ds_read_b64_tr_b16 v[34:35], v10 offset:8320
    ds_read_b64_tr_b16 v[36:37], v10 offset:8448
    ds_read_b64_tr_b16 v[38:39], v10 offset:8576
    ds_read_b64_tr_b16 v[40:41], v10 offset:10368
    ds_read_b64_tr_b16 v[42:43], v10 offset:10240
    ds_read_b64_tr_b16 v[44:45], v10 offset:10624
    ds_read_b64_tr_b16 v[46:47], v10 offset:10496
    ds_read_b64_tr_b16 v[48:49], v10 offset:12288
    ds_read_b64_tr_b16 v[50:51], v10 offset:12416
    ds_read_b64_tr_b16 v[52:53], v10 offset:12544
    ds_read_b64_tr_b16 v[54:55], v10 offset:12672
    ds_read_b64_tr_b16 v[56:57], v10 offset:14464
    ds_read_b64_tr_b16 v[58:59], v10 offset:14336
    ds_read_b64_tr_b16 v[60:61], v10 offset:14720
    ds_read_b64_tr_b16 v[62:63], v10 offset:14592
    s_waitcnt vmcnt(7)
    s_cmp_gt_u32 s17, 192
    s_cbranch_scc1 L_x192
    s_waitcnt vmcnt(5)
    s_cmp_gt_u32 s16, 192
    s_cbranch_scc1 L_x192
    s_waitcnt vmcnt(4)
L_x192:
    s_add_u32 m0, s63, 0
    s_add_u32 s67, s64, 262144
    buffer_load_dwordx4 v2, s[32:35], s67 offen offset:0 nt lds
    s_waitcnt lgkmcnt(0)
    v_readfirstlane_b32 s16, v242
    v_readfirstlane_b32 s17, v243
    v_mfma_f32_4x4x4_16b_bf16 v[96:99], v[20:21], v[32:33], v[96:99] cbsz:4 abid:0
    v_mfma_f32_4x4x4_16b_bf16 v[100:103], v[20:21], v[34:35], v[100:103] cbsz:4 abid:0
    v_mfma_f32_4x4x4_16b_bf16 v[104:107], v[20:21], v[36:37], v[104:107] cbsz:4 abid:0
    v_mfma_f32_4x4x4_16b_bf16 v[108:111], v[20:21], v[38:39], v[108:111] cbsz:4 abid:0
    v_mfma_f32_4x4x4_16b_bf16 v[96:99], v[20:21], v[40:41], v[96:99] cbsz:4 abid:4
    v_mfma_f32_4x4x4_16b_bf16 v[100:103], v[20:21], v[42:43], v[100:103] cbsz:4 abid:4
    v_mfma_f32_4x4x4_16b_bf16 v[104:107], v[20:21], v[44:45], v[104:107] cbsz:4 abid:4
    v_mfma_f32_4x4x4_16b_bf16 v[108:111], v[20:21], v[46:47], v[108:111] cbsz:4 abid:4
    v_mfma_f32_4x4x4_16b_bf16 v[96:99], v[20:21], v[48:49], v[96:99] cbsz:4 abid:8
    v_mfma_f32_4x4x4_16b_bf16 v[100:103], v[20:21], v[50:51], v[100:103] cbsz:4 abid:8
    v_mfma_f32_4x4x4_16b_bf16 v[104:107], v[20:21], v[52:53], v[104:107] cbsz:4 abid:8
    v_mfma_f32_4x4x4_16b_bf16 v[108:111], v[20:21], v[54:55], v[108:111] cbsz:4 abid:8
    v_mfma_f32_4x4x4_16b_bf16 v[96:99], v[20:21], v[56:57], v[96:99] cbsz:4 abid:12
    v_mfma_f32_4x4x4_16b_bf16 v[100:103], v[20:21], v[58:59], v[100:103] cbsz:4 abid:12
    v_mfma_f32_4x4x4_16b_bf16 v[104:107], v[20:21], v[60:61], v[104:107] cbsz:4 abid:12
    v_mfma_f32_4x4x4_16b_bf16 v[108:111], v[20:21], v[62:63], v[108:111] cbsz:4 abid:12
    s_waitcnt vmcnt(7)
    s_cmp_gt_u32 s17, 193
    s_cbranch_scc1 L_x193
    s_waitcnt vmcnt(5)
    s_cmp_gt_u32 s16, 193
    s_cbranch_scc1 L_x193
    s_waitcnt vmcnt(4)
L_x193:
    buffer_load_dwordx4 v3, s[32:35], s67 offen offset:1024 nt lds
    v_fma_f32 v28, v188, s65, -v19
    v_fma_f32 v29, v189, s65, -v19
    v_fma_f32 v30, v190, s65, -v19
    v_fma_f32 v31, v191, s65, -v19
    v_exp_f32 v28, v28
    v_exp_f32 v29, v29
    v_exp_f32 v30, v30
    v_exp_f32 v31, v31
    s_nop 0
    v_cvt_pk_bf16_f32 v22, v28, v29
    v_cvt_pk_bf16_f32 v23, v30, v31
    s_waitcnt vmcnt(7)
    s_cmp_gt_u32 s17, 194
    s_cbranch_scc1 L_x194
    s_waitcnt vmcnt(5)
    s_cmp_gt_u32 s16, 194
    s_cbranch_scc1 L_x194
    s_waitcnt vmcnt(4)
L_x194:
    s_add_u32 s67, s64, 268288
    buffer_load_dwordx4 v4, s[32:35], s67 offen offset:2048 nt lds
    s_waitcnt vmcnt(7)
    s_cmp_gt_u32 s17, 195
    s_cbranch_scc1 L_x195
    s_waitcnt vmcnt(5)
    s_cmp_gt_u32 s16, 195
    s_cbranch_scc1 L_x195
    s_waitcnt vmcnt(4)
L_x195:
    buffer_load_dwordx4 v5, s[32:35], s67 offen offset:3072 nt lds
    s_waitcnt vmcnt(7)
    s_cmp_gt_u32 s17, 196
    s_cbranch_scc1 L_x196
    s_waitcnt vmcnt(5)
    s_cmp_gt_u32 s16, 196
    s_cbranch_scc1 L_x196
    s_waitcnt vmcnt(4)
L_x196:
    s_add_u32 m0, s63, 4096
    s_add_u32 s67, s64, 278528
    buffer_load_dwordx4 v2, s[32:35], s67 offen offset:0 nt lds
    s_waitcnt vmcnt(7)
    s_cmp_gt_u32 s17, 197
    s_cbranch_scc1 L_x197
    s_waitcnt vmcnt(5)
    s_cmp_gt_u32 s16, 197
    s_cbranch_scc1 L_x197
    s_waitcnt vmcnt(4)
L_x197:
    buffer_load_dwordx4 v3, s[32:35], s67 offen offset:1024 nt lds
    s_waitcnt vmcnt(7)
    s_cmp_gt_u32 s17, 198
    s_cbranch_scc1 L_x198
    s_waitcnt vmcnt(5)
    s_cmp_gt_u32 s16, 198
    s_cbranch_scc1 L_x198
    s_waitcnt vmcnt(4)
L_x198:
    s_add_u32 s67, s64, 284672
    buffer_load_dwordx4 v4, s[32:35], s67 offen offset:2048 nt lds
    s_waitcnt vmcnt(7)
    s_cmp_gt_u32 s17, 199
    s_cbranch_scc1 L_x199
    s_waitcnt vmcnt(5)
    s_cmp_gt_u32 s16, 199
    s_cbranch_scc1 L_x199
    s_waitcnt vmcnt(4)
L_x199:
    buffer_load_dwordx4 v5, s[32:35], s67 offen offset:3072 nt lds
    v_mov_b32 v255, 1
    s_mov_b64 exec, 1
    ds_add_rtn_u32 v255, v254, v255 offset:24
    s_mov_b64 exec, -1
    ds_read_b64 v[242:243], v254
    ds_read_b64_tr_b16 v[32:33], v10 offset:16384
    ds_read_b64_tr_b16 v[34:35], v10 offset:16512
    ds_read_b64_tr_b16 v[36:37], v10 offset:16640
    ds_read_b64_tr_b16 v[38:39], v10 offset:16768
    ds_read_b64_tr_b16 v[40:41], v10 offset:18560
    ds_read_b64_tr_b16 v[42:43], v10 offset:18432
    ds_read_b64_tr_b16 v[44:45], v10 offset:18816
    ds_read_b64_tr_b16 v[46:47], v10 offset:18688
    ds_read_b64_tr_b16 v[48:49], v10 offset:20480
    ds_read_b64_tr_b16 v[50:51], v10 offset:20608
    ds_read_b64_tr_b16 v[52:53], v10 offset:20736
    ds_read_b64_tr_b16 v[54:55], v10 offset:20864
    ds_read_b64_tr_b16 v[56:57], v10 offset:22656
    ds_read_b64_tr_b16 v[58:59], v10 offset:22528
    ds_read_b64_tr_b16 v[60:61], v10 offset:22912
    ds_read_b64_tr_b16 v[62:63], v10 offset:22784
    s_waitcnt vmcnt(7)
    s_cmp_gt_u32 s17, 200
    s_cbranch_scc1 L_x200
    s_waitcnt vmcnt(5)
    s_cmp_gt_u32 s16, 200
    s_cbranch_scc1 L_x200
    s_waitcnt vmcnt(4)
L_x200:
    s_add_u32 m0, s63, 8192
    s_add_u32 s67, s64, 4456448
    buffer_load_dwordx4 v2, s[32:35], s67 offen offset:0 nt lds
    s_waitcnt lgkmcnt(0)
    v_readfirstlane_b32 s16, v242
    v_readfirstlane_b32 s17, v243
    v_readfirstlane_b32 s14, v255
    s_sub_u32 s14, s14, s15
    s_cmp_eq_u32 s14, 0
    s_cbranch_scc0 L_ra4_23
    s_mov_b32 s18, 1
    s_atomic_add s18, s[22:23], 139264 glc
L_ra4_23:
    v_mfma_f32_4x4x4_16b_bf16 v[96:99], v[22:23], v[32:33], v[96:99] cbsz:4 abid:0
    v_mfma_f32_4x4x4_16b_bf16 v[100:103], v[22:23], v[34:35], v[100:103] cbsz:4 abid:0
    v_mfma_f32_4x4x4_16b_bf16 v[104:107], v[22:23], v[36:37], v[104:107] cbsz:4 abid:0
    v_mfma_f32_4x4x4_16b_bf16 v[108:111], v[22:23], v[38:39], v[108:111] cbsz:4 abid:0
    v_mfma_f32_4x4x4_16b_bf16 v[96:99], v[22:23], v[40:41], v[96:99] cbsz:4 abid:4
    v_mfma_f32_4x4x4_16b_bf16 v[100:103], v[22:23], v[42:43], v[100:103] cbsz:4 abid:4
    v_mfma_f32_4x4x4_16b_bf16 v[104:107], v[22:23], v[44:45], v[104:107] cbsz:4 abid:4
    v_mfma_f32_4x4x4_16b_bf16 v[108:111], v[22:23], v[46:47], v[108:111] cbsz:4 abid:4
    v_mfma_f32_4x4x4_16b_bf16 v[96:99], v[22:23], v[48:49], v[96:99] cbsz:4 abid:8
    v_mfma_f32_4x4x4_16b_bf16 v[100:103], v[22:23], v[50:51], v[100:103] cbsz:4 abid:8
    v_mfma_f32_4x4x4_16b_bf16 v[104:107], v[22:23], v[52:53], v[104:107] cbsz:4 abid:8
    v_mfma_f32_4x4x4_16b_bf16 v[108:111], v[22:23], v[54:55], v[108:111] cbsz:4 abid:8
    v_mfma_f32_4x4x4_16b_bf16 v[96:99], v[22:23], v[56:57], v[96:99] cbsz:4 abid:12
    v_mfma_f32_4x4x4_16b_bf16 v[100:103], v[22:23], v[58:59], v[100:103] cbsz:4 abid:12
    v_mfma_f32_4x4x4_16b_bf16 v[104:107], v[22:23], v[60:61], v[104:107] cbsz:4 abid:12
    v_mfma_f32_4x4x4_16b_bf16 v[108:111], v[22:23], v[62:63], v[108:111] cbsz:4 abid:12
    s_waitcnt vmcnt(7)
    s_cmp_gt_u32 s17, 201
    s_cbranch_scc1 L_x201
    s_waitcnt vmcnt(5)
    s_cmp_gt_u32 s16, 201
    s_cbranch_scc1 L_x201
    s_waitcnt vmcnt(4)
L_x201:
    buffer_load_dwordx4 v3, s[32:35], s67 offen offset:1024 nt lds
    v_fma_f32 v28, v192, s65, -v19
    v_fma_f32 v29, v193, s65, -v19
    v_fma_f32 v30, v194, s65, -v19
    v_fma_f32 v31, v195, s65, -v19
    v_exp_f32 v28, v28
    v_exp_f32 v29, v29
    v_exp_f32 v30, v30
    v_exp_f32 v31, v31
    s_nop 0
    v_cvt_pk_bf16_f32 v20, v28, v29
    v_cvt_pk_bf16_f32 v21, v30, v31
    s_waitcnt vmcnt(7)
    s_cmp_gt_u32 s17, 202
    s_cbranch_scc1 L_x202
    s_waitcnt vmcnt(5)
    s_cmp_gt_u32 s16, 202
    s_cbranch_scc1 L_x202
    s_waitcnt vmcnt(4)
L_x202:
    s_add_u32 s67, s64, 4462592
    buffer_load_dwordx4 v4, s[32:35], s67 offen offset:2048 nt lds
    s_waitcnt vmcnt(7)
    s_cmp_gt_u32 s17, 203
    s_cbranch_scc1 L_x203
    s_waitcnt vmcnt(5)
    s_cmp_gt_u32 s16, 203
    s_cbranch_scc1 L_x203
    s_waitcnt vmcnt(4)
L_x203:
    buffer_load_dwordx4 v5, s[32:35], s67 offen offset:3072 nt lds
    s_waitcnt vmcnt(7)
    s_cmp_gt_u32 s17, 204
    s_cbranch_scc1 L_x204
    s_waitcnt vmcnt(5)
    s_cmp_gt_u32 s16, 204
    s_cbranch_scc1 L_x204
    s_waitcnt vmcnt(4)
L_x204:
    s_add_u32 m0, s63, 12288
    s_add_u32 s67, s64, 4472832
    buffer_load_dwordx4 v2, s[32:35], s67 offen offset:0 nt lds
    s_waitcnt vmcnt(7)
    s_cmp_gt_u32 s17, 205
    s_cbranch_scc1 L_x205
    s_waitcnt vmcnt(5)
    s_cmp_gt_u32 s16, 205
    s_cbranch_scc1 L_x205
    s_waitcnt vmcnt(4)
L_x205:
    buffer_load_dwordx4 v3, s[32:35], s67 offen offset:1024 nt lds
    s_waitcnt vmcnt(7)
    s_cmp_gt_u32 s17, 206
    s_cbranch_scc1 L_x206
    s_waitcnt vmcnt(5)
    s_cmp_gt_u32 s16, 206
    s_cbranch_scc1 L_x206
    s_waitcnt vmcnt(4)
L_x206:
    s_add_u32 s67, s64, 4478976
    buffer_load_dwordx4 v4, s[32:35], s67 offen offset:2048 nt lds
    s_waitcnt vmcnt(7)
    s_cmp_gt_u32 s17, 207
    s_cbranch_scc1 L_x207
    s_waitcnt vmcnt(5)
    s_cmp_gt_u32 s16, 207
    s_cbranch_scc1 L_x207
    s_waitcnt vmcnt(4)
L_x207:
    buffer_load_dwordx4 v5, s[32:35], s67 offen offset:3072 nt lds
    ds_read_b64 v[242:243], v254
    ds_read_b64_tr_b16 v[32:33], v10 offset:0
    ds_read_b64_tr_b16 v[34:35], v10 offset:128
    ds_read_b64_tr_b16 v[36:37], v10 offset:256
    ds_read_b64_tr_b16 v[38:39], v10 offset:384
    ds_read_b64_tr_b16 v[40:41], v10 offset:2176
    ds_read_b64_tr_b16 v[42:43], v10 offset:2048
    ds_read_b64_tr_b16 v[44:45], v10 offset:2432
    ds_read_b64_tr_b16 v[46:47], v10 offset:2304
    ds_read_b64_tr_b16 v[48:49], v10 offset:4096
    ds_read_b64_tr_b16 v[50:51], v10 offset:4224
    ds_read_b64_tr_b16 v[52:53], v10 offset:4352
    ds_read_b64_tr_b16 v[54:55], v10 offset:4480
    ds_read_b64_tr_b16 v[56:57], v10 offset:6272
    ds_read_b64_tr_b16 v[58:59], v10 offset:6144
    ds_read_b64_tr_b16 v[60:61], v10 offset:6528
    ds_read_b64_tr_b16 v[62:63], v10 offset:6400
    s_waitcnt vmcnt(7)
    s_cmp_gt_u32 s17, 208
    s_cbranch_scc1 L_x208
    s_waitcnt vmcnt(5)
    s_cmp_gt_u32 s16, 208
    s_cbranch_scc1 L_x208
    s_waitcnt vmcnt(4)
L_x208:
    s_add_u32 m0, s63, 16384
    s_add_u32 s67, s64, 8650752
    buffer_load_dwordx4 v2, s[32:35], s67 offen offset:0 nt lds
    s_waitcnt lgkmcnt(0)
    v_readfirstlane_b32 s16, v242
    v_readfirstlane_b32 s17, v243
    s_cmp_eq_u32 s14, 0
    s_cbranch_scc0 L_rkd4_0
    s_sub_u32 s16, s18, 18
    s_mul_i32 s16, s16, 6
    s_add_u32 s16, s16, 213
    s_cmp_gt_u32 s18, 18
    s_cselect_b32 s16, s16, 0
    s_sub_u32 s17, s18, 26
    s_mul_i32 s17, s17, 6
    s_add_u32 s17, s17, 213
    s_cmp_gt_u32 s18, 26
    s_cselect_b32 s17, s17, 0
    v_mov_b32 v242, s16
    v_mov_b32 v243, s17
    ds_write_b64 v254, v[242:243]
L_rkd4_0:
    v_mfma_f32_4x4x4_16b_bf16 v[96:99], v[20:21], v[32:33], v[96:99] cbsz:4 abid:0
    v_mfma_f32_4x4x4_16b_bf16 v[100:103], v[20:21], v[34:35], v[100:103] cbsz:4 abid:0
    v_mfma_f32_4x4x4_16b_bf16 v[104:107], v[20:21], v[36:37], v[104:107] cbsz:4 abid:0
    v_mfma_f32_4x4x4_16b_bf16 v[108:111], v[20:21], v[38:39], v[108:111] cbsz:4 abid:0
    v_mfma_f32_4x4x4_16b_bf16 v[96:99], v[20:21], v[40:41], v[96:99] cbsz:4 abid:4
    v_mfma_f32_4x4x4_16b_bf16 v[100:103], v[20:21], v[42:43], v[100:103] cbsz:4 abid:4
    v_mfma_f32_4x4x4_16b_bf16 v[104:107], v[20:21], v[44:45], v[104:107] cbsz:4 abid:4
    v_mfma_f32_4x4x4_16b_bf16 v[108:111], v[20:21], v[46:47], v[108:111] cbsz:4 abid:4
    v_mfma_f32_4x4x4_16b_bf16 v[96:99], v[20:21], v[48:49], v[96:99] cbsz:4 abid:8
    v_mfma_f32_4x4x4_16b_bf16 v[100:103], v[20:21], v[50:51], v[100:103] cbsz:4 abid:8
    v_mfma_f32_4x4x4_16b_bf16 v[104:107], v[20:21], v[52:53], v[104:107] cbsz:4 abid:8
    v_mfma_f32_4x4x4_16b_bf16 v[108:111], v[20:21], v[54:55], v[108:111] cbsz:4 abid:8
    v_mfma_f32_4x4x4_16b_bf16 v[96:99], v[20:21], v[56:57], v[96:99] cbsz:4 abid:12
    v_mfma_f32_4x4x4_16b_bf16 v[100:103], v[20:21], v[58:59], v[100:103] cbsz:4 abid:12
    v_mfma_f32_4x4x4_16b_bf16 v[104:107], v[20:21], v[60:61], v[104:107] cbsz:4 abid:12
    v_mfma_f32_4x4x4_16b_bf16 v[108:111], v[20:21], v[62:63], v[108:111] cbsz:4 abid:12
    s_waitcnt vmcnt(7)
    s_cmp_gt_u32 s17, 209
    s_cbranch_scc1 L_x209
    s_waitcnt vmcnt(5)
    s_cmp_gt_u32 s16, 209
    s_cbranch_scc1 L_x209
    s_waitcnt vmcnt(4)
L_x209:
    buffer_load_dwordx4 v3, s[32:35], s67 offen offset:1024 nt lds
    v_fma_f32 v28, v196, s65, -v19
    v_fma_f32 v29, v197, s65, -v19
    v_fma_f32 v30, v198, s65, -v19
    v_fma_f32 v31, v199, s65, -v19
    v_exp_f32 v28, v28
    v_exp_f32 v29, v29
    v_exp_f32 v30, v30
    v_exp_f32 v31, v31
    s_nop 0
    v_cvt_pk_bf16_f32 v22, v28, v29
    v_cvt_pk_bf16_f32 v23, v30, v31
    s_waitcnt vmcnt(7)
    s_cmp_gt_u32 s17, 210
    s_cbranch_scc1 L_x210
    s_waitcnt vmcnt(5)
    s_cmp_gt_u32 s16, 210
    s_cbranch_scc1 L_x210
    s_waitcnt vmcnt(4)
L_x210:
    s_add_u32 s67, s64, 8656896
    buffer_load_dwordx4 v4, s[32:35], s67 offen offset:2048 nt lds
    s_waitcnt vmcnt(7)
    s_cmp_gt_u32 s17, 211
    s_cbranch_scc1 L_x211
    s_waitcnt vmcnt(5)
    s_cmp_gt_u32 s16, 211
    s_cbranch_scc1 L_x211
    s_waitcnt vmcnt(4)
L_x211:
    buffer_load_dwordx4 v5, s[32:35], s67 offen offset:3072 nt lds
    s_waitcnt vmcnt(7)
    s_cmp_gt_u32 s17, 212
    s_cbranch_scc1 L_x212
    s_waitcnt vmcnt(5)
    s_cmp_gt_u32 s16, 212
    s_cbranch_scc1 L_x212
    s_waitcnt vmcnt(4)
L_x212:
    s_add_u32 m0, s63, 20480
    s_add_u32 s67, s64, 8667136
    buffer_load_dwordx4 v2, s[32:35], s67 offen offset:0 nt lds
    s_waitcnt vmcnt(7)
    s_cmp_gt_u32 s17, 213
    s_cbranch_scc1 L_x213
    s_waitcnt vmcnt(5)
    s_cmp_gt_u32 s16, 213
    s_cbranch_scc1 L_x213
    s_waitcnt vmcnt(4)
L_x213:
    buffer_load_dwordx4 v3, s[32:35], s67 offen offset:1024 nt lds
    s_waitcnt vmcnt(7)
    s_cmp_gt_u32 s17, 214
    s_cbranch_scc1 L_x214
    s_waitcnt vmcnt(5)
    s_cmp_gt_u32 s16, 214
    s_cbranch_scc1 L_x214
    s_waitcnt vmcnt(4)
L_x214:
    s_add_u32 s67, s64, 8673280
    buffer_load_dwordx4 v4, s[32:35], s67 offen offset:2048 nt lds
    s_waitcnt vmcnt(7)
    s_cmp_gt_u32 s17, 215
    s_cbranch_scc1 L_x215
    s_waitcnt vmcnt(5)
    s_cmp_gt_u32 s16, 215
    s_cbranch_scc1 L_x215
    s_waitcnt vmcnt(4)
L_x215:
    buffer_load_dwordx4 v5, s[32:35], s67 offen offset:3072 nt lds
    ds_read_b64 v[242:243], v254
    ds_read_b64_tr_b16 v[32:33], v10 offset:8192
    ds_read_b64_tr_b16 v[34:35], v10 offset:8320
    ds_read_b64_tr_b16 v[36:37], v10 offset:8448
    ds_read_b64_tr_b16 v[38:39], v10 offset:8576
    ds_read_b64_tr_b16 v[40:41], v10 offset:10368
    ds_read_b64_tr_b16 v[42:43], v10 offset:10240
    ds_read_b64_tr_b16 v[44:45], v10 offset:10624
    ds_read_b64_tr_b16 v[46:47], v10 offset:10496
    ds_read_b64_tr_b16 v[48:49], v10 offset:12288
    ds_read_b64_tr_b16 v[50:51], v10 offset:12416
    ds_read_b64_tr_b16 v[52:53], v10 offset:12544
    ds_read_b64_tr_b16 v[54:55], v10 offset:12672
    ds_read_b64_tr_b16 v[56:57], v10 offset:14464
    ds_read_b64_tr_b16 v[58:59], v10 offset:14336
    ds_read_b64_tr_b16 v[60:61], v10 offset:14720
    ds_read_b64_tr_b16 v[62:63], v10 offset:14592
    s_waitcnt vmcnt(7)
    s_cmp_gt_u32 s17, 216
    s_cbranch_scc1 L_x216
    s_waitcnt vmcnt(5)
    s_cmp_gt_u32 s16, 216
    s_cbranch_scc1 L_x216
    s_waitcnt vmcnt(4)
L_x216:
    s_add_u32 m0, s63, 0
    s_add_u32 s67, s64, 12845056
    buffer_load_dwordx4 v2, s[32:35], s67 offen offset:0 nt lds
    s_waitcnt lgkmcnt(0)
    v_readfirstlane_b32 s16, v242
    v_readfirstlane_b32 s17, v243
    v_mfma_f32_4x4x4_16b_bf16 v[96:99], v[22:23], v[32:33], v[96:99] cbsz:4 abid:0
    v_mfma_f32_4x4x4_16b_bf16 v[100:103], v[22:23], v[34:35], v[100:103] cbsz:4 abid:0
    v_mfma_f32_4x4x4_16b_bf16 v[104:107], v[22:23], v[36:37], v[104:107] cbsz:4 abid:0
    v_mfma_f32_4x4x4_16b_bf16 v[108:111], v[22:23], v[38:39], v[108:111] cbsz:4 abid:0
    v_mfma_f32_4x4x4_16b_bf16 v[96:99], v[22:23], v[40:41], v[96:99] cbsz:4 abid:4
    v_mfma_f32_4x4x4_16b_bf16 v[100:103], v[22:23], v[42:43], v[100:103] cbsz:4 abid:4
    v_mfma_f32_4x4x4_16b_bf16 v[104:107], v[22:23], v[44:45], v[104:107] cbsz:4 abid:4
    v_mfma_f32_4x4x4_16b_bf16 v[108:111], v[22:23], v[46:47], v[108:111] cbsz:4 abid:4
    v_mfma_f32_4x4x4_16b_bf16 v[96:99], v[22:23], v[48:49], v[96:99] cbsz:4 abid:8
    v_mfma_f32_4x4x4_16b_bf16 v[100:103], v[22:23], v[50:51], v[100:103] cbsz:4 abid:8
    v_mfma_f32_4x4x4_16b_bf16 v[104:107], v[22:23], v[52:53], v[104:107] cbsz:4 abid:8
    v_mfma_f32_4x4x4_16b_bf16 v[108:111], v[22:23], v[54:55], v[108:111] cbsz:4 abid:8
    v_mfma_f32_4x4x4_16b_bf16 v[96:99], v[22:23], v[56:57], v[96:99] cbsz:4 abid:12
    v_mfma_f32_4x4x4_16b_bf16 v[100:103], v[22:23], v[58:59], v[100:103] cbsz:4 abid:12
    v_mfma_f32_4x4x4_16b_bf16 v[104:107], v[22:23], v[60:61], v[104:107] cbsz:4 abid:12
    v_mfma_f32_4x4x4_16b_bf16 v[108:111], v[22:23], v[62:63], v[108:111] cbsz:4 abid:12
    s_waitcnt vmcnt(7)
    s_cmp_gt_u32 s17, 217
    s_cbranch_scc1 L_x217
    s_waitcnt vmcnt(5)
    s_cmp_gt_u32 s16, 217
    s_cbranch_scc1 L_x217
    s_waitcnt vmcnt(4)
L_x217:
    buffer_load_dwordx4 v3, s[32:35], s67 offen offset:1024 nt lds
    s_lshl_b32 s80, s60, 10
    s_add_u32 s80, s80, 32768
    v_lshlrev_b32 v232, 4, v1
    buffer_load_dwordx4 v[236:239], v232, s[48:51], s80 offen sc1
    s_waitcnt vmcnt(8)
    s_cmp_gt_u32 s17, 218
    s_cbranch_scc1 L_x218
    s_waitcnt vmcnt(6)
    s_cmp_gt_u32 s16, 218
    s_cbranch_scc1 L_x218
    s_waitcnt vmcnt(5)
L_x218:
    s_add_u32 s67, s64, 12851200
    buffer_load_dwordx4 v4, s[32:35], s67 offen offset:2048 nt lds
    v_fma_f32 v28, v200, s65, -v19
    v_fma_f32 v29, v201, s65, -v19
    v_fma_f32 v30, v202, s65, -v19
    v_fma_f32 v31, v203, s65, -v19
    v_exp_f32 v28, v28
    v_exp_f32 v29, v29
    v_exp_f32 v30, v30
    v_exp_f32 v31, v31
    s_nop 0
    v_cvt_pk_bf16_f32 v20, v28, v29
    v_cvt_pk_bf16_f32 v21, v30, v31
    s_waitcnt vmcnt(8)
    s_cmp_gt_u32 s17, 219
    s_cbranch_scc1 L_x219
    s_waitcnt vmcnt(6)
    s_cmp_gt_u32 s16, 219
    s_cbranch_scc1 L_x219
    s_waitcnt vmcnt(5)
L_x219:
    buffer_load_dwordx4 v5, s[32:35], s67 offen offset:3072 nt lds
    s_waitcnt vmcnt(8)
    s_cmp_gt_u32 s17, 220
    s_cbranch_scc1 L_x220
    s_waitcnt vmcnt(6)
    s_cmp_gt_u32 s16, 220
    s_cbranch_scc1 L_x220
    s_waitcnt vmcnt(5)
L_x220:
    s_add_u32 m0, s63, 4096
    s_add_u32 s67, s64, 12861440
    buffer_load_dwordx4 v2, s[32:35], s67 offen offset:0 nt lds
    s_waitcnt vmcnt(8)
    s_cmp_gt_u32 s17, 221
    s_cbranch_scc1 L_x221
    s_waitcnt vmcnt(6)
    s_cmp_gt_u32 s16, 221
    s_cbranch_scc1 L_x221
    s_waitcnt vmcnt(5)
L_x221:
    buffer_load_dwordx4 v3, s[32:35], s67 offen offset:1024 nt lds
    s_waitcnt vmcnt(8)
    s_cmp_gt_u32 s17, 222
    s_cbranch_scc1 L_x222
    s_waitcnt vmcnt(6)
    s_cmp_gt_u32 s16, 222
    s_cbranch_scc1 L_x222
    s_waitcnt vmcnt(5)
L_x222:
    s_add_u32 s67, s64, 12867584
    buffer_load_dwordx4 v4, s[32:35], s67 offen offset:2048 nt lds
    s_waitcnt vmcnt(8)
    s_cmp_gt_u32 s17, 223
    s_cbranch_scc1 L_x223
    s_waitcnt vmcnt(6)
    s_cmp_gt_u32 s16, 223
    s_cbranch_scc1 L_x223
    s_waitcnt vmcnt(4)
L_x223:
    buffer_load_dwordx4 v5, s[32:35], s67 offen offset:3072 nt lds
    v_mov_b32 v255, 1
    s_mov_b64 exec, 1
    ds_add_rtn_u32 v255, v254, v255 offset:28
    s_mov_b64 exec, -1
    ds_read_b64 v[242:243], v254
    ds_read_b64_tr_b16 v[32:33], v10 offset:16384
    ds_read_b64_tr_b16 v[34:35], v10 offset:16512
    ds_read_b64_tr_b16 v[36:37], v10 offset:16640
    ds_read_b64_tr_b16 v[38:39], v10 offset:16768
    ds_read_b64_tr_b16 v[40:41], v10 offset:18560
    ds_read_b64_tr_b16 v[42:43], v10 offset:18432
    ds_read_b64_tr_b16 v[44:45], v10 offset:18816
    ds_read_b64_tr_b16 v[46:47], v10 offset:18688
    ds_read_b64_tr_b16 v[48:49], v10 offset:20480
    ds_read_b64_tr_b16 v[50:51], v10 offset:20608
    ds_read_b64_tr_b16 v[52:53], v10 offset:20736
    ds_read_b64_tr_b16 v[54:55], v10 offset:20864
    ds_read_b64_tr_b16 v[56:57], v10 offset:22656
    ds_read_b64_tr_b16 v[58:59], v10 offset:22528
    ds_read_b64_tr_b16 v[60:61], v10 offset:22912
    ds_read_b64_tr_b16 v[62:63], v10 offset:22784
    s_waitcnt vmcnt(8)
    s_cmp_gt_u32 s17, 224
    s_cbranch_scc1 L_x224
    s_waitcnt vmcnt(5)
    s_cmp_gt_u32 s16, 224
    s_cbranch_scc1 L_x224
    s_waitcnt vmcnt(4)
L_x224:
    s_add_u32 m0, s63, 8192
    s_add_u32 s67, s64, 393216
    buffer_load_dwordx4 v2, s[32:35], s67 offen offset:0 nt lds
    s_waitcnt lgkmcnt(0)
    v_readfirstlane_b32 s16, v242
    v_readfirstlane_b32 s17, v243
    v_readfirstlane_b32 s14, v255
    s_sub_u32 s14, s14, s15
    s_cmp_eq_u32 s14, 0
    s_cbranch_scc0 L_ra5_26
    s_mov_b32 s18, 1
    s_atomic_add s18, s[22:23], 174080 glc
L_ra5_26:
    v_mfma_f32_4x4x4_16b_bf16 v[96:99], v[20:21], v[32:33], v[96:99] cbsz:4 abid:0
    v_mfma_f32_4x4x4_16b_bf16 v[100:103], v[20:21], v[34:35], v[100:103] cbsz:4 abid:0
    v_mfma_f32_4x4x4_16b_bf16 v[104:107], v[20:21], v[36:37], v[104:107] cbsz:4 abid:0
    v_mfma_f32_4x4x4_16b_bf16 v[108:111], v[20:21], v[38:39], v[108:111] cbsz:4 abid:0
    v_mfma_f32_4x4x4_16b_bf16 v[96:99], v[20:21], v[40:41], v[96:99] cbsz:4 abid:4
    v_mfma_f32_4x4x4_16b_bf16 v[100:103], v[20:21], v[42:43], v[100:103] cbsz:4 abid:4
    v_mfma_f32_4x4x4_16b_bf16 v[104:107], v[20:21], v[44:45], v[104:107] cbsz:4 abid:4
    v_mfma_f32_4x4x4_16b_bf16 v[108:111], v[20:21], v[46:47], v[108:111] cbsz:4 abid:4
    v_mfma_f32_4x4x4_16b_bf16 v[96:99], v[20:21], v[48:49], v[96:99] cbsz:4 abid:8
    v_mfma_f32_4x4x4_16b_bf16 v[100:103], v[20:21], v[50:51], v[100:103] cbsz:4 abid:8
    v_mfma_f32_4x4x4_16b_bf16 v[104:107], v[20:21], v[52:53], v[104:107] cbsz:4 abid:8
    v_mfma_f32_4x4x4_16b_bf16 v[108:111], v[20:21], v[54:55], v[108:111] cbsz:4 abid:8
    v_mfma_f32_4x4x4_16b_bf16 v[96:99], v[20:21], v[56:57], v[96:99] cbsz:4 abid:12
    v_mfma_f32_4x4x4_16b_bf16 v[100:103], v[20:21], v[58:59], v[100:103] cbsz:4 abid:12
    v_mfma_f32_4x4x4_16b_bf16 v[104:107], v[20:21], v[60:61], v[104:107] cbsz:4 abid:12
    v_mfma_f32_4x4x4_16b_bf16 v[108:111], v[20:21], v[62:63], v[108:111] cbsz:4 abid:12
    s_waitcnt vmcnt(8)
    s_cmp_gt_u32 s17, 225
    s_cbranch_scc1 L_x225
    s_waitcnt vmcnt(5)
    s_cmp_gt_u32 s16, 225
    s_cbranch_scc1 L_x225
    s_waitcnt vmcnt(4)
L_x225:
    buffer_load_dwordx4 v3, s[32:35], s67 offen offset:1024 nt lds
    s_waitcnt vmcnt(8)
    s_mov_b32 s72, 4000000
L_mlchk:
    v_xor_b32 v233, s62, v237
    v_xor_b32 v234, s62, v239
    v_and_or_b32 v233, v234, -16, v233
    v_cmp_ne_u32 vcc, 0, v233
    s_cbranch_vccz L_mlok
    s_sub_u32 s72, s72, 1
    s_cbranch_scc1 L_mlok
    buffer_load_dwordx4 v[236:239], v232, s[48:51], s80 offen sc1
    s_waitcnt vmcnt(0)
    s_branch L_mlchk
L_mlok:
    v_cmp_ne_u32 vcc, s83, v234
    s_cmp_eq_u64 vcc, 0
    s_cselect_b32 s82, 1, 0
    v_mov_b32 v233, v236
    s_nop 1
    v_max_f32_dpp v233, v233, v233 row_ror:2 row_mask:0xf bank_mask:0xf
    s_nop 1
    v_max_f32_dpp v233, v233, v233 row_ror:4 row_mask:0xf bank_mask:0xf
    s_nop 1
    v_max_f32_dpp v233, v233, v233 row_ror:8 row_mask:0xf bank_mask:0xf
    v_mov_b32 v234, v233
    s_nop 1
    v_permlane16_swap_b32 v233, v234
    s_nop 0
    v_max_f32 v233, v233, v234
    v_mov_b32 v234, v233
    s_nop 1
    v_permlane32_swap_b32 v233, v234
    s_nop 0
    v_max_f32 v233, v233, v234
    s_waitcnt vmcnt(7)
    s_cmp_gt_u32 s17, 226
    s_cbranch_scc1 L_x226
    s_waitcnt vmcnt(5)
    s_cmp_gt_u32 s16, 226
    s_cbranch_scc1 L_x226
    s_waitcnt vmcnt(4)
L_x226:
    s_add_u32 s67, s64, 399360
    buffer_load_dwordx4 v4, s[32:35], s67 offen offset:2048 nt lds
    v_sub_f32 v236, v236, v233
    v_exp_f32 v236, v236
    s_nop 0
    v_mul_f32 v238, v238, v236
    s_nop 1
    v_add_f32_dpp v238, v238, v238 row_ror:2 row_mask:0xf bank_mask:0xf
    s_nop 1
    v_add_f32_dpp v238, v238, v238 row_ror:4 row_mask:0xf bank_mask:0xf
    s_nop 1
    v_add_f32_dpp v238, v238, v238 row_ror:8 row_mask:0xf bank_mask:0xf
    v_mov_b32 v234, v238
    s_nop 1
    v_permlane16_swap_b32 v238, v234
    s_nop 0
    v_add_f32 v238, v238, v234
    v_mov_b32 v234, v238
    s_nop 1
    v_permlane32_swap_b32 v238, v234
    s_nop 0
    v_add_f32 v238, v238, v234
    v_log_f32 v238, v238
    s_nop 0
    v_add_f32 v233, v233, v238
    v_sub_f32 v234, v19, v233
    v_exp_f32 v234, v234
    s_waitcnt vmcnt(7)
    s_cmp_gt_u32 s17, 227
    s_cbranch_scc1 L_x227
    s_waitcnt vmcnt(5)
    s_cmp_gt_u32 s16, 227
    s_cbranch_scc1 L_x227
    s_waitcnt vmcnt(4)
L_x227:
    buffer_load_dwordx4 v5, s[32:35], s67 offen offset:3072 nt lds
    v_fma_f32 v28, v204, s65, -v19
    v_fma_f32 v29, v205, s65, -v19
    v_fma_f32 v30, v206, s65, -v19
    v_fma_f32 v31, v207, s65, -v19
    v_exp_f32 v28, v28
    v_exp_f32 v29, v29
    v_exp_f32 v30, v30
    v_exp_f32 v31, v31
    s_nop 0
    v_cvt_pk_bf16_f32 v22, v28, v29
    v_cvt_pk_bf16_f32 v23, v30, v31
    s_waitcnt vmcnt(7)
    s_cmp_gt_u32 s17, 228
    s_cbranch_scc1 L_x228
    s_waitcnt vmcnt(5)
    s_cmp_gt_u32 s16, 228
    s_cbranch_scc1 L_x228
    s_waitcnt vmcnt(4)
L_x228:
    s_add_u32 m0, s63, 12288
    s_add_u32 s67, s64, 409600
    buffer_load_dwordx4 v2, s[32:35], s67 offen offset:0 nt lds
    s_waitcnt vmcnt(7)
    s_cmp_gt_u32 s17, 229
    s_cbranch_scc1 L_x229
    s_waitcnt vmcnt(5)
    s_cmp_gt_u32 s16, 229
    s_cbranch_scc1 L_x229
    s_waitcnt vmcnt(4)
L_x229:
    buffer_load_dwordx4 v3, s[32:35], s67 offen offset:1024 nt lds
    s_waitcnt vmcnt(7)
    s_cmp_gt_u32 s17, 230
    s_cbranch_scc1 L_x230
    s_waitcnt vmcnt(5)
    s_cmp_gt_u32 s16, 230
    s_cbranch_scc1 L_x230
    s_waitcnt vmcnt(4)
L_x230:
    s_add_u32 s67, s64, 415744
    buffer_load_dwordx4 v4, s[32:35], s67 offen offset:2048 nt lds
    s_waitcnt vmcnt(7)
    s_cmp_gt_u32 s17, 231
    s_cbranch_scc1 L_x231
    s_waitcnt vmcnt(5)
    s_cmp_gt_u32 s16, 231
    s_cbranch_scc1 L_x231
    s_waitcnt vmcnt(4)
L_x231:
    buffer_load_dwordx4 v5, s[32:35], s67 offen offset:3072 nt lds
    ds_read_b64 v[242:243], v254
    ds_read_b64_tr_b16 v[32:33], v10 offset:0
    ds_read_b64_tr_b16 v[34:35], v10 offset:128
    ds_read_b64_tr_b16 v[36:37], v10 offset:256
    ds_read_b64_tr_b16 v[38:39], v10 offset:384
    ds_read_b64_tr_b16 v[40:41], v10 offset:2176
    ds_read_b64_tr_b16 v[42:43], v10 offset:2048
    ds_read_b64_tr_b16 v[44:45], v10 offset:2432
    ds_read_b64_tr_b16 v[46:47], v10 offset:2304
    ds_read_b64_tr_b16 v[48:49], v10 offset:4096
    ds_read_b64_tr_b16 v[50:51], v10 offset:4224
    ds_read_b64_tr_b16 v[52:53], v10 offset:4352
    ds_read_b64_tr_b16 v[54:55], v10 offset:4480
    ds_read_b64_tr_b16 v[56:57], v10 offset:6272
    ds_read_b64_tr_b16 v[58:59], v10 offset:6144
    ds_read_b64_tr_b16 v[60:61], v10 offset:6528
    ds_read_b64_tr_b16 v[62:63], v10 offset:6400
    s_waitcnt vmcnt(7)
    s_cmp_gt_u32 s17, 232
    s_cbranch_scc1 L_x232
    s_waitcnt vmcnt(5)
    s_cmp_gt_u32 s16, 232
    s_cbranch_scc1 L_x232
    s_waitcnt vmcnt(4)
L_x232:
    s_add_u32 m0, s63, 16384
    s_add_u32 s67, s64, 4587520
    buffer_load_dwordx4 v2, s[32:35], s67 offen offset:0 nt lds
    s_waitcnt lgkmcnt(0)
    v_readfirstlane_b32 s16, v242
    v_readfirstlane_b32 s17, v243
    s_cmp_eq_u32 s14, 0
    s_cbranch_scc0 L_rkd5_0
    s_sub_u32 s16, s18, 14
    s_mul_i32 s16, s16, 8
    s_add_u32 s16, s16, 237
    s_cmp_gt_u32 s18, 14
    s_cselect_b32 s16, s16, 0
    s_sub_u32 s17, s18, 22
    s_mul_i32 s17, s17, 8
    s_add_u32 s17, s17, 237
    s_cmp_gt_u32 s18, 22
    s_cselect_b32 s17, s17, 0
    v_mov_b32 v242, s16
    v_mov_b32 v243, s17
    ds_write_b64 v254, v[242:243]
L_rkd5_0:
    v_mfma_f32_4x4x4_16b_bf16 v[96:99], v[22:23], v[32:33], v[96:99] cbsz:4 abid:0
    v_mfma_f32_4x4x4_16b_bf16 v[100:103], v[22:23], v[34:35], v[100:103] cbsz:4 abid:0
    v_mfma_f32_4x4x4_16b_bf16 v[104:107], v[22:23], v[36:37], v[104:107] cbsz:4 abid:0
    v_mfma_f32_4x4x4_16b_bf16 v[108:111], v[22:23], v[38:39], v[108:111] cbsz:4 abid:0
    v_mfma_f32_4x4x4_16b_bf16 v[96:99], v[22:23], v[40:41], v[96:99] cbsz:4 abid:4
    v_mfma_f32_4x4x4_16b_bf16 v[100:103], v[22:23], v[42:43], v[100:103] cbsz:4 abid:4
    v_mfma_f32_4x4x4_16b_bf16 v[104:107], v[22:23], v[44:45], v[104:107] cbsz:4 abid:4
    v_mfma_f32_4x4x4_16b_bf16 v[108:111], v[22:23], v[46:47], v[108:111] cbsz:4 abid:4
    v_mfma_f32_4x4x4_16b_bf16 v[96:99], v[22:23], v[48:49], v[96:99] cbsz:4 abid:8
    v_mfma_f32_4x4x4_16b_bf16 v[100:103], v[22:23], v[50:51], v[100:103] cbsz:4 abid:8
    v_mfma_f32_4x4x4_16b_bf16 v[104:107], v[22:23], v[52:53], v[104:107] cbsz:4 abid:8
    v_mfma_f32_4x4x4_16b_bf16 v[108:111], v[22:23], v[54:55], v[108:111] cbsz:4 abid:8
    v_mfma_f32_4x4x4_16b_bf16 v[96:99], v[22:23], v[56:57], v[96:99] cbsz:4 abid:12
    v_mfma_f32_4x4x4_16b_bf16 v[100:103], v[22:23], v[58:59], v[100:103] cbsz:4 abid:12
    v_mfma_f32_4x4x4_16b_bf16 v[104:107], v[22:23], v[60:61], v[104:107] cbsz:4 abid:12
    v_mfma_f32_4x4x4_16b_bf16 v[108:111], v[22:23], v[62:63], v[108:111] cbsz:4 abid:12
    s_waitcnt vmcnt(7)
    s_cmp_gt_u32 s17, 233
    s_cbranch_scc1 L_x233
    s_waitcnt vmcnt(5)
    s_cmp_gt_u32 s16, 233
    s_cbranch_scc1 L_x233
    s_waitcnt vmcnt(4)
L_x233:
    buffer_load_dwordx4 v3, s[32:35], s67 offen offset:1024 nt lds
    v_mov_b32 v19, v233
    s_nop 0
    v_mov_b32_dpp v226, v234 quad_perm:[0,0,0,0] row_mask:0xf bank_mask:0xf
    v_mov_b32_dpp v227, v234 quad_perm:[1,1,1,1] row_mask:0xf bank_mask:0xf
    s_nop 4
    v_pk_mul_f32 v[96:97], v[96:97], v[226:227]
    v_pk_mul_f32 v[100:101], v[100:101], v[226:227]
    v_pk_mul_f32 v[104:105], v[104:105], v[226:227]
    v_pk_mul_f32 v[108:109], v[108:109], v[226:227]
    s_waitcnt vmcnt(7)
    s_cmp_gt_u32 s17, 234
    s_cbranch_scc1 L_x234
    s_waitcnt vmcnt(5)
    s_cmp_gt_u32 s16, 234
    s_cbranch_scc1 L_x234
    s_waitcnt vmcnt(4)
L_x234:
    s_add_u32 s67, s64, 4593664
    buffer_load_dwordx4 v4, s[32:35], s67 offen offset:2048 nt lds
    v_fma_f32 v28, v208, s65, -v19
    v_fma_f32 v29, v209, s65, -v19
    v_fma_f32 v30, v210, s65, -v19
    v_fma_f32 v31, v211, s65, -v19
    v_exp_f32 v28, v28
    v_exp_f32 v29, v29
    v_exp_f32 v30, v30
    v_exp_f32 v31, v31
    s_nop 0
    v_cvt_pk_bf16_f32 v20, v28, v29
    v_cvt_pk_bf16_f32 v21, v30, v31
    s_waitcnt vmcnt(7)
    s_cmp_gt_u32 s17, 235
    s_cbranch_scc1 L_x235
    s_waitcnt vmcnt(5)
    s_cmp_gt_u32 s16, 235
    s_cbranch_scc1 L_x235
    s_waitcnt vmcnt(4)
L_x235:
    buffer_load_dwordx4 v5, s[32:35], s67 offen offset:3072 nt lds
    s_waitcnt vmcnt(7)
    s_cmp_gt_u32 s17, 236
    s_cbranch_scc1 L_x236
    s_waitcnt vmcnt(5)
    s_cmp_gt_u32 s16, 236
    s_cbranch_scc1 L_x236
    s_waitcnt vmcnt(4)
L_x236:
    s_add_u32 m0, s63, 20480
    s_add_u32 s67, s64, 4603904
    buffer_load_dwordx4 v2, s[32:35], s67 offen offset:0 nt lds
    s_waitcnt vmcnt(7)
    s_cmp_gt_u32 s17, 237
    s_cbranch_scc1 L_x237
    s_waitcnt vmcnt(5)
    s_cmp_gt_u32 s16, 237
    s_cbranch_scc1 L_x237
    s_waitcnt vmcnt(4)
L_x237:
    buffer_load_dwordx4 v3, s[32:35], s67 offen offset:1024 nt lds
    s_waitcnt vmcnt(7)
    s_cmp_gt_u32 s17, 238
    s_cbranch_scc1 L_x238
    s_waitcnt vmcnt(5)
    s_cmp_gt_u32 s16, 238
    s_cbranch_scc1 L_x238
    s_waitcnt vmcnt(4)
L_x238:
    s_add_u32 s67, s64, 4610048
    buffer_load_dwordx4 v4, s[32:35], s67 offen offset:2048 nt lds
    s_waitcnt vmcnt(7)
    s_cmp_gt_u32 s17, 239
    s_cbranch_scc1 L_x239
    s_waitcnt vmcnt(5)
    s_cmp_gt_u32 s16, 239
    s_cbranch_scc1 L_x239
    s_waitcnt vmcnt(4)
L_x239:
    buffer_load_dwordx4 v5, s[32:35], s67 offen offset:3072 nt lds
    ds_read_b64 v[242:243], v254
    ds_read_b64_tr_b16 v[32:33], v10 offset:8192
    ds_read_b64_tr_b16 v[34:35], v10 offset:8320
    ds_read_b64_tr_b16 v[36:37], v10 offset:8448
    ds_read_b64_tr_b16 v[38:39], v10 offset:8576
    ds_read_b64_tr_b16 v[40:41], v10 offset:10368
    ds_read_b64_tr_b16 v[42:43], v10 offset:10240
    ds_read_b64_tr_b16 v[44:45], v10 offset:10624
    ds_read_b64_tr_b16 v[46:47], v10 offset:10496
    ds_read_b64_tr_b16 v[48:49], v10 offset:12288
    ds_read_b64_tr_b16 v[50:51], v10 offset:12416
    ds_read_b64_tr_b16 v[52:53], v10 offset:12544
    ds_read_b64_tr_b16 v[54:55], v10 offset:12672
    ds_read_b64_tr_b16 v[56:57], v10 offset:14464
    ds_read_b64_tr_b16 v[58:59], v10 offset:14336
    ds_read_b64_tr_b16 v[60:61], v10 offset:14720
    ds_read_b64_tr_b16 v[62:63], v10 offset:14592
    s_waitcnt vmcnt(7)
    s_cmp_gt_u32 s17, 240
    s_cbranch_scc1 L_x240
    s_waitcnt vmcnt(5)
    s_cmp_gt_u32 s16, 240
    s_cbranch_scc1 L_x240
    s_waitcnt vmcnt(4)
L_x240:
    s_add_u32 m0, s63, 0
    s_add_u32 s67, s64, 8781824
    buffer_load_dwordx4 v2, s[32:35], s67 offen offset:0 nt lds
    s_waitcnt lgkmcnt(0)
    v_readfirstlane_b32 s16, v242
    v_readfirstlane_b32 s17, v243
    v_mfma_f32_4x4x4_16b_bf16 v[96:99], v[20:21], v[32:33], v[96:99] cbsz:4 abid:0
    v_mfma_f32_4x4x4_16b_bf16 v[100:103], v[20:21], v[34:35], v[100:103] cbsz:4 abid:0
    v_mfma_f32_4x4x4_16b_bf16 v[104:107], v[20:21], v[36:37], v[104:107] cbsz:4 abid:0
    v_mfma_f32_4x4x4_16b_bf16 v[108:111], v[20:21], v[38:39], v[108:111] cbsz:4 abid:0
    v_mfma_f32_4x4x4_16b_bf16 v[96:99], v[20:21], v[40:41], v[96:99] cbsz:4 abid:4
    v_mfma_f32_4x4x4_16b_bf16 v[100:103], v[20:21], v[42:43], v[100:103] cbsz:4 abid:4
    v_mfma_f32_4x4x4_16b_bf16 v[104:107], v[20:21], v[44:45], v[104:107] cbsz:4 abid:4
    v_mfma_f32_4x4x4_16b_bf16 v[108:111], v[20:21], v[46:47], v[108:111] cbsz:4 abid:4
    v_mfma_f32_4x4x4_16b_bf16 v[96:99], v[20:21], v[48:49], v[96:99] cbsz:4 abid:8
    v_mfma_f32_4x4x4_16b_bf16 v[100:103], v[20:21], v[50:51], v[100:103] cbsz:4 abid:8
    v_mfma_f32_4x4x4_16b_bf16 v[104:107], v[20:21], v[52:53], v[104:107] cbsz:4 abid:8
    v_mfma_f32_4x4x4_16b_bf16 v[108:111], v[20:21], v[54:55], v[108:111] cbsz:4 abid:8
    v_mfma_f32_4x4x4_16b_bf16 v[96:99], v[20:21], v[56:57], v[96:99] cbsz:4 abid:12
    v_mfma_f32_4x4x4_16b_bf16 v[100:103], v[20:21], v[58:59], v[100:103] cbsz:4 abid:12
    v_mfma_f32_4x4x4_16b_bf16 v[104:107], v[20:21], v[60:61], v[104:107] cbsz:4 abid:12
    v_mfma_f32_4x4x4_16b_bf16 v[108:111], v[20:21], v[62:63], v[108:111] cbsz:4 abid:12
    s_waitcnt vmcnt(7)
    s_cmp_gt_u32 s17, 241
    s_cbranch_scc1 L_x241
    s_waitcnt vmcnt(5)
    s_cmp_gt_u32 s16, 241
    s_cbranch_scc1 L_x241
    s_waitcnt vmcnt(4)
L_x241:
    buffer_load_dwordx4 v3, s[32:35], s67 offen offset:1024 nt lds
    s_add_u32 s74, s63, 16384
    v_lshlrev_b32 v6, 4, v1
    v_add_u32 v6, s74, v6
    v_lshlrev_b32 v8, 4, v1
    v_add_u32 v8, 16384, v8
    s_lshr_b32 s74, s3, 1
    s_lshl_b32 s74, s74, 7
    s_and_b32 s75, s3, 1
    s_add_u32 s74, s74, s75
    s_lshl_b32 s74, s74, 3
    v_add_u32 v8, s74, v8
    v_add_u32 v9, 49152, v8
    s_lshl_b32 s68, s60, 5
    s_add_u32 s68, s68, s61
    s_lshl_b32 s72, s60, 6
    s_add_u32 s72, s72, s61
    s_mul_i32 s72, s72, 7168
    s_mul_i32 s73, s66, 7168
    s_lshl_b32 s68, s68, 12
    s_add_u32 s68, s68, 65536
    s_lshl_b32 s27, s3, 10
    s_add_u32 s27, s27, s68
    v_lshlrev_b32 v228, 4, v1
    v_mov_b32 v65, s62
    v_mov_b32 v69, s62
    v_mov_b32 v71, s62
    v_cmp_gt_u32 vcc, 224, v0
    v_lshlrev_b32 v225, 2, v0
    v_lshrrev_b32 v235, 3, v0
    v_and_b32 v226, 7, v0
    v_lshlrev_b32 v226, 4, v226
    v_lshl_add_u32 v235, v235, 12, v226
    s_add_u32 s71, s62, 2
    v_bfrev_b32 v226, 2
    v_cndmask_b32 v240, v226, v225, vcc
    v_cndmask_b32 v235, v226, v235, vcc
    s_waitcnt vmcnt(7)
    s_cmp_gt_u32 s17, 242
    s_cbranch_scc1 L_x242
    s_waitcnt vmcnt(5)
    s_cmp_gt_u32 s16, 242
    s_cbranch_scc1 L_x242
    s_waitcnt vmcnt(4)
L_x242:
    s_add_u32 s67, s64, 8787968
    buffer_load_dwordx4 v4, s[32:35], s67 offen offset:2048 nt lds
    v_lshrrev_b32 v224, 3, v1
    v_and_b32 v225, 7, v1
    v_lshlrev_b32 v225, 4, v225
    v_lshl_add_u32 v229, v224, 12, v225
    s_lshl_b32 s74, s60, 17
    s_lshl_b32 s75, s61, 7
    s_add_u32 s74, s74, s75
    s_add_u32 s74, s74, 65536
    s_add_u32 s75, s74, 32768
    s_add_u32 s76, s74, 65536
    s_add_u32 s77, s74, 98304
    s_add_u32 s4, s68, 0
    s_add_u32 s5, s68, 1024
    s_add_u32 s6, s68, 2048
    s_add_u32 s7, s68, 3072
    s_lshl_b32 s8, s2, 7
    s_add_u32 s8, s8, 2031616
    s_sub_u32 s78, s2, 224
    s_cmp_lt_u32 s78, 28
    s_cselect_b32 s70, 1, 0
    s_cselect_b32 s78, s78, 0
    s_lshl_b32 s9, s78, 10
    s_add_u32 s9, s9, 2031616
    s_lshl_b32 s78, s78, 5
    v_lshrrev_b32 v233, 5, v1
    v_lshl_add_u32 v232, v233, 3, v225
    v_lshrrev_b32 v241, 2, v232
    v_add_u32 v241, s78, v241
    v_and_b32 v238, 1, v1
    v_mul_u32_u24 v238, 2093056, v238
    s_movk_i32 s20, 0xff
    s_movk_i32 s21, 0xff
    s_waitcnt vmcnt(7)
    s_cmp_gt_u32 s17, 243
    s_cbranch_scc1 L_x243
    s_waitcnt vmcnt(5)
    s_cmp_gt_u32 s16, 243
    s_cbranch_scc1 L_x243
    s_waitcnt vmcnt(4)
L_x243:
    buffer_load_dwordx4 v5, s[32:35], s67 offen offset:3072 nt lds
    v_fma_f32 v28, v212, s65, -v19
    v_fma_f32 v29, v213, s65, -v19
    v_fma_f32 v30, v214, s65, -v19
    v_fma_f32 v31, v215, s65, -v19
    v_exp_f32 v28, v28
    v_exp_f32 v29, v29
    v_exp_f32 v30, v30
    v_exp_f32 v31, v31
    s_nop 0
    v_cvt_pk_bf16_f32 v22, v28, v29
    v_cvt_pk_bf16_f32 v23, v30, v31
    s_waitcnt vmcnt(7)
    s_cmp_gt_u32 s17, 244
    s_cbranch_scc1 L_x244
    s_waitcnt vmcnt(5)
    s_cmp_gt_u32 s16, 244
    s_cbranch_scc1 L_x244
    s_waitcnt vmcnt(4)
L_x244:
    s_add_u32 m0, s63, 4096
    s_add_u32 s67, s64, 8798208
    buffer_load_dwordx4 v2, s[32:35], s67 offen offset:0 nt lds
    s_waitcnt vmcnt(7)
    s_cmp_gt_u32 s17, 245
    s_cbranch_scc1 L_x245
    s_waitcnt vmcnt(5)
    s_cmp_gt_u32 s16, 245
    s_cbranch_scc1 L_x245
    s_waitcnt vmcnt(4)
L_x245:
    buffer_load_dwordx4 v3, s[32:35], s67 offen offset:1024 nt lds
    s_waitcnt vmcnt(7)
    s_cmp_gt_u32 s17, 246
    s_cbranch_scc1 L_x246
    s_waitcnt vmcnt(5)
    s_cmp_gt_u32 s16, 246
    s_cbranch_scc1 L_x246
    s_waitcnt vmcnt(4)
L_x246:
    s_add_u32 s67, s64, 8804352
    buffer_load_dwordx4 v4, s[32:35], s67 offen offset:2048 nt lds
    s_waitcnt vmcnt(7)
    s_cmp_gt_u32 s17, 247
    s_cbranch_scc1 L_x247
    s_waitcnt vmcnt(5)
    s_cmp_gt_u32 s16, 247
    s_cbranch_scc1 L_x247
    s_waitcnt vmcnt(4)
L_x247:
    buffer_load_dwordx4 v5, s[32:35], s67 offen offset:3072 nt lds
    ds_read_b64_tr_b16 v[32:33], v10 offset:16384
    ds_read_b64_tr_b16 v[34:35], v10 offset:16512
    ds_read_b64_tr_b16 v[36:37], v10 offset:16640
    ds_read_b64_tr_b16 v[38:39], v10 offset:16768
    ds_read_b64_tr_b16 v[40:41], v10 offset:18560
    ds_read_b64_tr_b16 v[42:43], v10 offset:18432
    ds_read_b64_tr_b16 v[44:45], v10 offset:18816
    ds_read_b64_tr_b16 v[46:47], v10 offset:18688
    ds_read_b64_tr_b16 v[48:49], v10 offset:20480
    ds_read_b64_tr_b16 v[50:51], v10 offset:20608
    ds_read_b64_tr_b16 v[52:53], v10 offset:20736
    ds_read_b64_tr_b16 v[54:55], v10 offset:20864
    ds_read_b64_tr_b16 v[56:57], v10 offset:22656
    ds_read_b64_tr_b16 v[58:59], v10 offset:22528
    ds_read_b64_tr_b16 v[60:61], v10 offset:22912
    ds_read_b64_tr_b16 v[62:63], v10 offset:22784
    s_waitcnt vmcnt(7)
    s_cmp_gt_u32 s17, 248
    s_cbranch_scc1 L_x248
    s_waitcnt vmcnt(5)
    s_cmp_gt_u32 s16, 248
    s_cbranch_scc1 L_x248
    s_waitcnt vmcnt(4)
L_x248:
    s_add_u32 m0, s63, 8192
    s_add_u32 s67, s64, 12976128
    buffer_load_dwordx4 v2, s[32:35], s67 offen offset:0 nt lds
    s_waitcnt lgkmcnt(0)
    v_mfma_f32_4x4x4_16b_bf16 v[96:99], v[22:23], v[32:33], v[96:99] cbsz:4 abid:0
    v_mfma_f32_4x4x4_16b_bf16 v[100:103], v[22:23], v[34:35], v[100:103] cbsz:4 abid:0
    v_mfma_f32_4x4x4_16b_bf16 v[104:107], v[22:23], v[36:37], v[104:107] cbsz:4 abid:0
    v_mfma_f32_4x4x4_16b_bf16 v[108:111], v[22:23], v[38:39], v[108:111] cbsz:4 abid:0
    v_mfma_f32_4x4x4_16b_bf16 v[96:99], v[22:23], v[40:41], v[96:99] cbsz:4 abid:4
    v_mfma_f32_4x4x4_16b_bf16 v[100:103], v[22:23], v[42:43], v[100:103] cbsz:4 abid:4
    v_mfma_f32_4x4x4_16b_bf16 v[104:107], v[22:23], v[44:45], v[104:107] cbsz:4 abid:4
    v_mfma_f32_4x4x4_16b_bf16 v[108:111], v[22:23], v[46:47], v[108:111] cbsz:4 abid:4
    v_mfma_f32_4x4x4_16b_bf16 v[96:99], v[22:23], v[48:49], v[96:99] cbsz:4 abid:8
    v_mfma_f32_4x4x4_16b_bf16 v[100:103], v[22:23], v[50:51], v[100:103] cbsz:4 abid:8
    v_mfma_f32_4x4x4_16b_bf16 v[104:107], v[22:23], v[52:53], v[104:107] cbsz:4 abid:8
    v_mfma_f32_4x4x4_16b_bf16 v[108:111], v[22:23], v[54:55], v[108:111] cbsz:4 abid:8
    v_mfma_f32_4x4x4_16b_bf16 v[96:99], v[22:23], v[56:57], v[96:99] cbsz:4 abid:12
    v_mfma_f32_4x4x4_16b_bf16 v[100:103], v[22:23], v[58:59], v[100:103] cbsz:4 abid:12
    v_mfma_f32_4x4x4_16b_bf16 v[104:107], v[22:23], v[60:61], v[104:107] cbsz:4 abid:12
    v_mfma_f32_4x4x4_16b_bf16 v[108:111], v[22:23], v[62:63], v[108:111] cbsz:4 abid:12
    buffer_load_dwordx4 v3, s[32:35], s67 offen offset:1024 nt lds
    s_add_u32 s67, s64, 12982272
    buffer_load_dwordx4 v4, s[32:35], s67 offen offset:2048 nt lds
    buffer_load_dwordx4 v5, s[32:35], s67 offen offset:3072 nt lds
    s_add_u32 m0, s63, 12288
    s_add_u32 s67, s64, 12992512
    buffer_load_dwordx4 v2, s[32:35], s67 offen offset:0 nt lds
    s_waitcnt vmcnt(11)
    buffer_load_dwordx4 v3, s[32:35], s67 offen offset:1024 nt lds
    s_waitcnt vmcnt(11)
    s_add_u32 s67, s64, 12998656
    buffer_load_dwordx4 v4, s[32:35], s67 offen offset:2048 nt lds
    s_waitcnt vmcnt(11)
    buffer_load_dwordx4 v5, s[32:35], s67 offen offset:3072 nt lds
    s_lshl_b32 s80, s3, 15
    s_add_u32 s80, s80, s74
    buffer_load_dword v236, v229, s[48:51], s80 offen sc1
    v_fma_f32 v28, v216, s65, -v19
    v_fma_f32 v29, v217, s65, -v19
    v_fma_f32 v30, v218, s65, -v19
    v_fma_f32 v31, v219, s65, -v19
    v_exp_f32 v28, v28
    v_exp_f32 v29, v29
    v_exp_f32 v30, v30
    v_exp_f32 v31, v31
    s_nop 0
    v_cvt_pk_bf16_f32 v20, v28, v29
    v_cvt_pk_bf16_f32 v21, v30, v31
    v_fma_f32 v28, v220, s65, -v19
    v_fma_f32 v29, v221, s65, -v19
    v_fma_f32 v30, v222, s65, -v19
    v_fma_f32 v31, v223, s65, -v19
    v_exp_f32 v28, v28
    v_exp_f32 v29, v29
    v_exp_f32 v30, v30
    v_exp_f32 v31, v31
    s_nop 0
    v_cvt_pk_bf16_f32 v22, v28, v29
    v_cvt_pk_bf16_f32 v23, v30, v31
    s_waitcnt vmcnt(9)
    ds_read_b64_tr_b16 v[32:33], v10 offset:0
    ds_read_b64_tr_b16 v[34:35], v10 offset:128
    ds_read_b64_tr_b16 v[36:37], v10 offset:256
    ds_read_b64_tr_b16 v[38:39], v10 offset:384
    ds_read_b64_tr_b16 v[40:41], v10 offset:2176
    ds_read_b64_tr_b16 v[42:43], v10 offset:2048
    ds_read_b64_tr_b16 v[44:45], v10 offset:2432
    ds_read_b64_tr_b16 v[46:47], v10 offset:2304
    ds_read_b64_tr_b16 v[48:49], v10 offset:4096
    ds_read_b64_tr_b16 v[50:51], v10 offset:4224
    ds_read_b64_tr_b16 v[52:53], v10 offset:4352
    ds_read_b64_tr_b16 v[54:55], v10 offset:4480
    ds_read_b64_tr_b16 v[56:57], v10 offset:6272
    ds_read_b64_tr_b16 v[58:59], v10 offset:6144
    ds_read_b64_tr_b16 v[60:61], v10 offset:6528
    ds_read_b64_tr_b16 v[62:63], v10 offset:6400
    buffer_load_dword v164, v240, s[40:43], s72 offen offset:0 nt
    buffer_load_dword v166, v240, s[40:43], s72 offen offset:896 nt
    buffer_load_dword v168, v240, s[40:43], s72 offen offset:1792 nt
    buffer_load_dword v170, v240, s[40:43], s72 offen offset:2688 nt
    s_add_u32 s72, s72, 3584
    buffer_load_dword v172, v240, s[40:43], s72 offen offset:0 nt
    buffer_load_dword v174, v240, s[40:43], s72 offen offset:896 nt
    buffer_load_dword v176, v240, s[40:43], s72 offen offset:1792 nt
    buffer_load_dword v178, v240, s[40:43], s72 offen offset:2688 nt
    s_add_u32 s72, s72, 225792
    buffer_load_dword v165, v240, s[40:43], s72 offen offset:0 nt
    buffer_load_dword v167, v240, s[40:43], s72 offen offset:896 nt
    buffer_load_dword v169, v240, s[40:43], s72 offen offset:1792 nt
    buffer_load_dword v171, v240, s[40:43], s72 offen offset:2688 nt
    s_add_u32 s72, s72, 3584
    buffer_load_dword v173, v240, s[40:43], s72 offen offset:0 nt
    buffer_load_dword v175, v240, s[40:43], s72 offen offset:896 nt
    buffer_load_dword v177, v240, s[40:43], s72 offen offset:1792 nt
    buffer_load_dword v179, v240, s[40:43], s72 offen offset:2688 nt
    buffer_load_dword v180, v240, s[44:47], s73 offen offset:0 nt
    buffer_load_dword v181, v240, s[44:47], s73 offen offset:896 nt
    buffer_load_dword v182, v240, s[44:47], s73 offen offset:1792 nt
    buffer_load_dword v183, v240, s[44:47], s73 offen offset:2688 nt
    s_add_u32 s73, s73, 3584
    buffer_load_dword v184, v240, s[44:47], s73 offen offset:0 nt
    buffer_load_dword v185, v240, s[44:47], s73 offen offset:896 nt
    buffer_load_dword v186, v240, s[44:47], s73 offen offset:1792 nt
    buffer_load_dword v187, v240, s[44:47], s73 offen offset:2688 nt
    s_waitcnt lgkmcnt(0)
    v_mfma_f32_4x4x4_16b_bf16 v[96:99], v[20:21], v[32:33], v[96:99] cbsz:4 abid:0
    v_mfma_f32_4x4x4_16b_bf16 v[100:103], v[20:21], v[34:35], v[100:103] cbsz:4 abid:0
    v_mfma_f32_4x4x4_16b_bf16 v[104:107], v[20:21], v[36:37], v[104:107] cbsz:4 abid:0
    v_mfma_f32_4x4x4_16b_bf16 v[108:111], v[20:21], v[38:39], v[108:111] cbsz:4 abid:0
    v_mfma_f32_4x4x4_16b_bf16 v[96:99], v[20:21], v[40:41], v[96:99] cbsz:4 abid:4
    v_mfma_f32_4x4x4_16b_bf16 v[100:103], v[20:21], v[42:43], v[100:103] cbsz:4 abid:4
    v_mfma_f32_4x4x4_16b_bf16 v[104:107], v[20:21], v[44:45], v[104:107] cbsz:4 abid:4
    v_mfma_f32_4x4x4_16b_bf16 v[108:111], v[20:21], v[46:47], v[108:111] cbsz:4 abid:4
    v_mfma_f32_4x4x4_16b_bf16 v[96:99], v[20:21], v[48:49], v[96:99] cbsz:4 abid:8
    v_mfma_f32_4x4x4_16b_bf16 v[100:103], v[20:21], v[50:51], v[100:103] cbsz:4 abid:8
    v_mfma_f32_4x4x4_16b_bf16 v[104:107], v[20:21], v[52:53], v[104:107] cbsz:4 abid:8
    v_mfma_f32_4x4x4_16b_bf16 v[108:111], v[20:21], v[54:55], v[108:111] cbsz:4 abid:8
    v_mfma_f32_4x4x4_16b_bf16 v[96:99], v[20:21], v[56:57], v[96:99] cbsz:4 abid:12
    v_mfma_f32_4x4x4_16b_bf16 v[100:103], v[20:21], v[58:59], v[100:103] cbsz:4 abid:12
    v_mfma_f32_4x4x4_16b_bf16 v[104:107], v[20:21], v[60:61], v[104:107] cbsz:4 abid:12
    v_mfma_f32_4x4x4_16b_bf16 v[108:111], v[20:21], v[62:63], v[108:111] cbsz:4 abid:12
    s_waitcnt vmcnt(31)
    ds_read_b64_tr_b16 v[32:33], v10 offset:8192
    ds_read_b64_tr_b16 v[34:35], v10 offset:8320
    ds_read_b64_tr_b16 v[36:37], v10 offset:8448
    ds_read_b64_tr_b16 v[38:39], v10 offset:8576
    s_waitcnt vmcnt(29)
    ds_read_b64_tr_b16 v[40:41], v10 offset:10368
    ds_read_b64_tr_b16 v[42:43], v10 offset:10240
    ds_read_b64_tr_b16 v[44:45], v10 offset:10624
    ds_read_b64_tr_b16 v[46:47], v10 offset:10496
    s_waitcnt lgkmcnt(4)
    v_mfma_f32_4x4x4_16b_bf16 v[96:99], v[22:23], v[32:33], v[96:99] cbsz:4 abid:0
    v_mfma_f32_4x4x4_16b_bf16 v[100:103], v[22:23], v[34:35], v[100:103] cbsz:4 abid:0
    v_mfma_f32_4x4x4_16b_bf16 v[104:107], v[22:23], v[36:37], v[104:107] cbsz:4 abid:0
    v_mfma_f32_4x4x4_16b_bf16 v[108:111], v[22:23], v[38:39], v[108:111] cbsz:4 abid:0
    s_waitcnt vmcnt(27)
    ds_read_b64_tr_b16 v[48:49], v10 offset:12288
    ds_read_b64_tr_b16 v[50:51], v10 offset:12416
    ds_read_b64_tr_b16 v[52:53], v10 offset:12544
    ds_read_b64_tr_b16 v[54:55], v10 offset:12672
    s_waitcnt lgkmcnt(4)
    v_mfma_f32_4x4x4_16b_bf16 v[96:99], v[22:23], v[40:41], v[96:99] cbsz:4 abid:4
    v_mfma_f32_4x4x4_16b_bf16 v[100:103], v[22:23], v[42:43], v[100:103] cbsz:4 abid:4
    v_mfma_f32_4x4x4_16b_bf16 v[104:107], v[22:23], v[44:45], v[104:107] cbsz:4 abid:4
    v_mfma_f32_4x4x4_16b_bf16 v[108:111], v[22:23], v[46:47], v[108:111] cbsz:4 abid:4
    s_waitcnt vmcnt(25)
    ds_read_b64_tr_b16 v[56:57], v10 offset:14464
    ds_read_b64_tr_b16 v[58:59], v10 offset:14336
    ds_read_b64_tr_b16 v[60:61], v10 offset:14720
    ds_read_b64_tr_b16 v[62:63], v10 offset:14592
    s_waitcnt lgkmcnt(4)
    v_mfma_f32_4x4x4_16b_bf16 v[96:99], v[22:23], v[48:49], v[96:99] cbsz:4 abid:8
    v_mfma_f32_4x4x4_16b_bf16 v[100:103], v[22:23], v[50:51], v[100:103] cbsz:4 abid:8
    v_mfma_f32_4x4x4_16b_bf16 v[104:107], v[22:23], v[52:53], v[104:107] cbsz:4 abid:8
    v_mfma_f32_4x4x4_16b_bf16 v[108:111], v[22:23], v[54:55], v[108:111] cbsz:4 abid:8
    s_waitcnt lgkmcnt(0)
    v_mfma_f32_4x4x4_16b_bf16 v[96:99], v[22:23], v[56:57], v[96:99] cbsz:4 abid:12
    v_mfma_f32_4x4x4_16b_bf16 v[100:103], v[22:23], v[58:59], v[100:103] cbsz:4 abid:12
    v_mfma_f32_4x4x4_16b_bf16 v[104:107], v[22:23], v[60:61], v[104:107] cbsz:4 abid:12
    v_mfma_f32_4x4x4_16b_bf16 v[108:111], v[22:23], v[62:63], v[108:111] cbsz:4 abid:12
    s_nop 1
    s_nop 0
    ds_write2_b64 v6, v[96:97], v[100:101] offset0:0 offset1:1
    s_nop 0
    ds_write2_b64 v6, v[104:105], v[108:109] offset0:128 offset1:129
    s_waitcnt lgkmcnt(0)
    s_barrier
    ds_read_b64 v[32:33], v8 offset:0
    ds_read_b64 v[34:35], v8 offset:24576
    ds_read_b64 v[36:37], v9 offset:0
    ds_read_b64 v[38:39], v9 offset:24576
    s_cmp_eq_u32 s82, 1
    s_waitcnt lgkmcnt(2)
    v_pk_add_f32 v[32:33], v[32:33], v[34:35]
    s_waitcnt lgkmcnt(0)
    v_pk_add_f32 v[36:37], v[36:37], v[38:39]
    v_add_f32 v68, v32, v36
    v_add_f32 v70, v33, v37
    s_cbranch_scc0 L_far1
    buffer_store_dwordx4 v[68:71], v228, s[48:51], s27 offen
L_sent1:
    buffer_load_dwordx4 v[112:115], v229, s[48:51], s74 offen sc1
    buffer_load_dwordx4 v[116:119], v229, s[48:51], s75 offen sc1
    buffer_load_dwordx4 v[120:123], v229, s[48:51], s76 offen sc1
    buffer_load_dwordx4 v[124:127], v229, s[48:51], s77 offen sc1
    s_waitcnt vmcnt(5)
    s_mov_b32 s78, 0x05040100
    s_mov_b32 s79, 0x07060302
    v_perm_b32 v128, v165, v164, s78
    v_perm_b32 v129, v165, v164, s79
    v_perm_b32 v130, v167, v166, s78
    v_perm_b32 v131, v167, v166, s79
    v_perm_b32 v132, v169, v168, s78
    v_perm_b32 v133, v169, v168, s79
    v_perm_b32 v134, v171, v170, s78
    v_perm_b32 v135, v171, v170, s79
    v_perm_b32 v136, v173, v172, s78
    v_perm_b32 v137, v173, v172, s79
    v_perm_b32 v138, v175, v174, s78
    v_perm_b32 v139, v175, v174, s79
    v_perm_b32 v140, v177, v176, s78
    v_perm_b32 v141, v177, v176, s79
    v_perm_b32 v142, v179, v178, s78
    v_perm_b32 v143, v179, v178, s79
    v_perm_b32 v144, v181, v180, s78
    v_perm_b32 v145, v181, v180, s79
    v_perm_b32 v146, v183, v182, s78
    v_perm_b32 v147, v183, v182, s79
    v_perm_b32 v148, v185, v184, s78
    v_perm_b32 v149, v185, v184, s79
    v_perm_b32 v150, v187, v186, s78
    v_perm_b32 v151, v187, v186, s79
    v_mov_b32 v152, 0
    v_mov_b32 v153, s71
    v_mov_b32 v154, 0
    v_mov_b32 v155, s71
    s_cmp_lt_u32 s2, 224
    s_cbranch_scc0 L_noprep
    v_dot2_f32_bf16 v152, v244, v144, v152
    v_dot2_f32_bf16 v154, v244, v145, v154
    v_dot2_f32_bf16 v152, v246, v146, v152
    v_dot2_f32_bf16 v154, v246, v147, v154
    v_dot2_f32_bf16 v152, v248, v148, v152
    v_dot2_f32_bf16 v154, v248, v149, v154
    v_dot2_f32_bf16 v152, v250, v150, v152
    v_dot2_f32_bf16 v154, v250, v151, v154
L_noprep:
    s_mov_b32 s81, 4000000
L_h1:
    s_waitcnt vmcnt(3)
    v_xor_b32 v226, s62, v113
    v_bitop3_b32 v226, v226, v115, s62 bitop3:0xf6
    s_waitcnt vmcnt(2)
    v_bitop3_b32 v226, v226, v117, s62 bitop3:0xf6
    v_bitop3_b32 v226, v226, v119, s62 bitop3:0xf6
    v_add_f32 v224, v112, v116
    v_add_f32 v225, v114, v118
    s_waitcnt vmcnt(1)
    v_bitop3_b32 v226, v226, v121, s62 bitop3:0xf6
    v_bitop3_b32 v226, v226, v123, s62 bitop3:0xf6
    v_add_f32 v224, v224, v120
    v_add_f32 v225, v225, v122
    s_waitcnt vmcnt(0)
    v_bitop3_b32 v226, v226, v125, s62 bitop3:0xf6
    v_bitop3_b32 v226, v226, v127, s62 bitop3:0xf6
    v_cmp_ne_u32 vcc, 0, v226
    v_add_f32 v224, v224, v124
    v_add_f32 v225, v225, v126
    s_cbranch_vccz L_h1ok
    s_sub_u32 s81, s81, 1
    s_cbranch_scc1 L_h1ok
    buffer_load_dwordx4 v[112:115], v229, s[48:51], s74 offen sc1
    buffer_load_dwordx4 v[116:119], v229, s[48:51], s75 offen sc1
    buffer_load_dwordx4 v[120:123], v229, s[48:51], s76 offen sc1
    buffer_load_dwordx4 v[124:127], v229, s[48:51], s77 offen sc1
    s_branch L_h1
L_h1ok:
    s_nop 0
    v_add_f32_dpp v224, v224, v224 row_ror:8 row_mask:0xf bank_mask:0xf
    v_add_f32_dpp v225, v225, v225 row_ror:8 row_mask:0xf bank_mask:0xf
    v_mov_b32 v226, v224
    v_mov_b32 v227, v225
    s_nop 0
    v_permlane16_swap_b32 v224, v226
    v_permlane16_swap_b32 v225, v227
    v_add_f32 v224, v224, v226
    v_add_f32 v225, v225, v227
    v_mov_b32 v226, v224
    v_mov_b32 v227, v225
    s_nop 0
    v_permlane32_swap_b32 v224, v226
    v_permlane32_swap_b32 v225, v227
    v_add_f32 v224, v224, v226
    v_add_f32 v225, v225, v227
    v_cvt_pk_bf16_f32 v224, v224, v225
    s_cmp_eq_u32 s82, 1
    v_readlane_b32 s10, v224, 0
    v_readlane_b32 s11, v224, 1
    v_readlane_b32 s12, v224, 2
    v_readlane_b32 s13, v224, 3
    v_readlane_b32 s14, v224, 4
    v_readlane_b32 s15, v224, 5
    v_readlane_b32 s16, v224, 6
    v_readlane_b32 s17, v224, 7
    v_dot2_f32_bf16 v152, s10, v128, v152
    v_dot2_f32_bf16 v154, s10, v129, v154
    v_dot2_f32_bf16 v152, s11, v130, v152
    v_dot2_f32_bf16 v154, s11, v131, v154
    v_dot2_f32_bf16 v152, s12, v132, v152
    v_dot2_f32_bf16 v154, s12, v133, v154
    v_dot2_f32_bf16 v152, s13, v134, v152
    v_dot2_f32_bf16 v154, s13, v135, v154
    v_dot2_f32_bf16 v152, s14, v136, v152
    v_dot2_f32_bf16 v154, s14, v137, v154
    v_dot2_f32_bf16 v152, s15, v138, v152
    v_dot2_f32_bf16 v154, s15, v139, v154
    v_dot2_f32_bf16 v152, s16, v140, v152
    v_dot2_f32_bf16 v154, s16, v141, v154
    v_dot2_f32_bf16 v152, s17, v142, v152
    v_dot2_f32_bf16 v154, s17, v143, v154
    s_barrier
    s_nop 0
    s_cbranch_scc0 L_far2
    buffer_store_dwordx4 v[152:155], v235, s[48:51], s74 offen
L_sent2:
    s_cmp_eq_u32 s3, 0
    s_cbranch_scc0 L_stop
    s_mov_b32 s81, 4000000
    s_cmp_lt_u32 s61, 28
    s_cbranch_scc0 L_final
    buffer_load_dwordx4 v[112:115], v228, s[48:51], s4 offen sc1
    buffer_load_dwordx4 v[116:119], v228, s[48:51], s5 offen sc1
    buffer_load_dwordx4 v[120:123], v228, s[48:51], s6 offen sc1
    buffer_load_dwordx4 v[124:127], v228, s[48:51], s7 offen sc1
L_h2:
    s_waitcnt vmcnt(3)
    v_xor_b32 v226, s71, v113
    v_bitop3_b32 v226, v226, v115, s71 bitop3:0xf6
    s_waitcnt vmcnt(2)
    v_bitop3_b32 v226, v226, v117, s71 bitop3:0xf6
    v_bitop3_b32 v226, v226, v119, s71 bitop3:0xf6
    v_add_f32 v64, v112, v116
    v_add_f32 v66, v114, v118
    s_waitcnt vmcnt(1)
    v_bitop3_b32 v226, v226, v121, s71 bitop3:0xf6
    v_bitop3_b32 v226, v226, v123, s71 bitop3:0xf6
    v_add_f32 v64, v64, v120
    v_add_f32 v66, v66, v122
    s_waitcnt vmcnt(0)
    v_bitop3_b32 v226, v226, v125, s71 bitop3:0xf6
    v_bitop3_b32 v226, v226, v127, s71 bitop3:0xf6
    v_cmp_ne_u32 vcc, 0, v226
    v_add_f32 v64, v64, v124
    v_add_f32 v66, v66, v126
    s_cbranch_vccz L_h2ok
    s_sub_u32 s81, s81, 1
    s_cbranch_scc1 L_h2ok
    buffer_load_dwordx4 v[112:115], v228, s[48:51], s4 offen sc1
    buffer_load_dwordx4 v[116:119], v228, s[48:51], s5 offen sc1
    buffer_load_dwordx4 v[120:123], v228, s[48:51], s6 offen sc1
    buffer_load_dwordx4 v[124:127], v228, s[48:51], s7 offen sc1
    s_branch L_h2
L_h2ok:
    s_nop 0
    v_permlane32_swap_b32 v64, v66
    s_nop 0
    v_add_f32 v64, v64, v66
    s_nop 1
    v_add_f32_dpp v64, v64, v64 row_ror:8 row_mask:0xf bank_mask:0xf
    v_mov_b32 v224, v64
    s_nop 1
    v_permlane16_swap_b32 v64, v224
    s_nop 0
    v_add_f32 v64, v64, v224
    s_mov_b64 exec, s[20:21]
    buffer_store_dwordx2 v[64:65], v232, s[48:51], s8 offen sc1
L_stop:
    s_endpgm
L_final:
    s_cmp_eq_u32 s70, 1
    s_cbranch_scc0 L_stop
    v_mov_b32 v231, 0
    buffer_load_short_d16_hi v231, v241, s[52:55], 0 offen
    buffer_load_ushort v236, v241, s[56:59], 0 offen
    buffer_load_dword v237, v238, s[48:51], 0 offen
    buffer_load_dwordx4 v[112:115], v228, s[48:51], s9 offen sc1
    buffer_load_dwordx4 v[116:119], v228, s[48:51], s9 offen sc1
    buffer_load_dwordx4 v[120:123], v228, s[48:51], s9 offen sc1
L_h3:
    buffer_load_dwordx4 v[124:127], v228, s[48:51], s9 offen sc1
    s_waitcnt vmcnt(3)
    v_xor_b32 v224, s62, v113
    v_bitop3_b32 v224, v224, v115, s62 bitop3:0xf6
    v_cmp_ne_u32 vcc, 0, v224
    v_mov_b32 v64, v112
    v_mov_b32 v66, v114
    s_cbranch_vccz L_h3ok
    buffer_load_dwordx4 v[112:115], v228, s[48:51], s9 offen sc1
    s_waitcnt vmcnt(3)
    v_xor_b32 v224, s62, v117
    v_bitop3_b32 v224, v224, v119, s62 bitop3:0xf6
    v_cmp_ne_u32 vcc, 0, v224
    v_mov_b32 v64, v116
    v_mov_b32 v66, v118
    s_cbranch_vccz L_h3ok
    buffer_load_dwordx4 v[116:119], v228, s[48:51], s9 offen sc1
    s_waitcnt vmcnt(3)
    v_xor_b32 v224, s62, v121
    v_bitop3_b32 v224, v224, v123, s62 bitop3:0xf6
    v_cmp_ne_u32 vcc, 0, v224
    v_mov_b32 v64, v120
    v_mov_b32 v66, v122
    s_cbranch_vccz L_h3ok
    buffer_load_dwordx4 v[120:123], v228, s[48:51], s9 offen sc1
    s_waitcnt vmcnt(3)
    v_xor_b32 v224, s62, v125
    v_bitop3_b32 v224, v224, v127, s62 bitop3:0xf6
    v_cmp_ne_u32 vcc, 0, v224
    v_mov_b32 v64, v124
    v_mov_b32 v66, v126
    s_cbranch_vccz L_h3ok
    s_sub_u32 s81, s81, 1
    s_cbranch_scc0 L_h3
L_h3ok:
    s_nop 0
    v_permlane32_swap_b32 v64, v66
    s_nop 0
    v_add_f32 v64, v64, v66
    s_nop 1
    v_add_f32_dpp v64, v64, v64 row_ror:8 row_mask:0xf bank_mask:0xf
    v_mov_b32 v224, v64
    s_nop 1
    v_permlane16_swap_b32 v64, v224
    s_nop 0
    v_add_f32 v64, v64, v224
    v_add_f32 v64, v64, v231
    s_mov_b64 exec, s[20:21]
    v_cvt_pk_bf16_f32 v64, v64, v64
    buffer_store_short v64, v241, s[56:59], 0 offen
    s_cmp_eq_u32 s2, 224
    s_cbranch_scc0 L_fin_end
    s_mov_b64 exec, 3
    buffer_store_dword v65, v238, s[48:51], 0 offen
L_fin_end:
    s_endpgm
L_far1:
    buffer_store_dwordx4 v[68:71], v228, s[48:51], s27 offen sc1
    s_branch L_sent1
L_far2:
    buffer_store_dwordx4 v[152:155], v235, s[48:51], s74 offen sc1
    s_branch L_sent2
L_done:
L_end:
    s_endpgm
.section .rodata,"a"
.p2align 6
.amdhsa_kernel parallel_sum__gqa_block_cached__dense_activation_relu__decode_kernel
  .amdhsa_next_free_vgpr 512
  .amdhsa_next_free_sgpr 102
  .amdhsa_accum_offset 256
  .amdhsa_group_segment_fixed_size 0
  .amdhsa_kernarg_size 88
  .amdhsa_user_sgpr_count 2
  .amdhsa_user_sgpr_kernarg_segment_ptr 1
  .amdhsa_system_sgpr_workgroup_id_x 1
  .amdhsa_float_denorm_mode_32 3
.end_amdhsa_kernel
```
